```python
import torch

def _softmax(x, axis=-1):
    return torch.softmax(x, dim=axis)
def _gelu(x):
    return torch.nn.functional.gelu(x, approximate="tanh")
def _silu(x):
    return torch.nn.functional.silu(x)
def _sigmoid(x):
    return torch.sigmoid(x)
def _layernorm(x, axis=-1, eps=1e-5):
    m = x.mean(dim=axis, keepdim=True)
    v = x.var(dim=axis, keepdim=True, unbiased=False)
    return (x - m) / torch.sqrt(v + eps)
def _scatter_add(tgt, idx, src, axis=0):
    return tgt.clone().index_add_(axis, idx, src)
def _segment_sum(src, seg, n):
    out = torch.zeros((n,) + src.shape[1:], dtype=src.dtype)
    return out.index_add_(0, seg, src)
def _pad(x, pw):
    flat = tuple(v for pair in reversed(pw) for v in pair)
    return torch.nn.functional.pad(x, flat)

kernel_name = 'recurrent_scan__linear_kernel_hedgehog__dense_activation_silu__prompt'

def setup_inputs():

    _w = (lambda a: (lambda t: t.to(torch.bfloat16) if t.is_floating_point() else t)(torch.as_tensor(a)))
    def _A_setup():
        B, S, D, H = 1, 2048, 640, 32
        Dh = D // H
        return {
            "x": _w((lambda *s: torch.randn(*s, dtype=torch.bfloat16) * 0.05)(B, S, D)),
            "wqkv": _w((lambda *s: torch.randn(*s, dtype=torch.bfloat16) * 0.4)(D, 3 * D)),
            "w_phi": _w((lambda *s: torch.randn(*s, dtype=torch.bfloat16) * 0.4)(H, Dh, Dh) * (Dh ** -0.5)),
            "wo": _w((lambda *s: torch.randn(*s, dtype=torch.bfloat16) * 0.2)(D, D)),
        }
    _A_in = _A_setup()

    def _B_setup():
        B, S, D, F = 1, 2048, 640, 1536
        return {
            "x": _w((lambda *s: torch.randn(*s, dtype=torch.bfloat16) * 0.05)(B, S, D)),
            "w1": _w((lambda *s: torch.randn(*s, dtype=torch.bfloat16) * 0.4)(D, F) * (D ** -0.5)),
            "w2": _w((lambda *s: torch.randn(*s, dtype=torch.bfloat16) * 0.1)(F, D) * (F ** -0.5)),
        }
    _B_in = _B_setup()

    return {
        "A_x": _A_in["x"],
        "A_wqkv": _A_in["wqkv"],
        "A_w_phi": _A_in["w_phi"],
        "A_wo": _A_in["wo"],
        "B_x": _B_in["x"],
        "B_w1": _B_in["w1"],
        "B_w2": _B_in["w2"],
    }

def reference(A_x, A_wqkv, A_w_phi, A_wo, B_x, B_w1, B_w2):
    def _A_ref(x, wqkv, w_phi, wo):
        B, S, D = x.shape
        H = 32; Dh = D // H
        qkv = (lambda x, *d: x.permute(*d))((x @ wqkv).reshape(B, S, 3, H, Dh), 2, 0, 3, 1, 4)
        q, k, v = qkv[0], qkv[1], qkv[2]
        pq = torch.einsum("bhsd,hdf->bhsf", q, w_phi)
        pk = torch.einsum("bhsd,hdf->bhsf", k, w_phi)
        phi_q = torch.concatenate([_softmax(pq, axis=-1), _softmax(-pq, axis=-1)], axis=-1)
        phi_k = torch.concatenate([_softmax(pk, axis=-1), _softmax(-pk, axis=-1)], axis=-1)
        kv = torch.einsum("bhsf,bhsd->bhfd", phi_k, v)
        z  = torch.einsum("bhsf->bhf", phi_k)
        num = torch.einsum("bhqf,bhfd->bhqd", phi_q, kv)
        den = torch.einsum("bhqf,bhf->bhq", phi_q, z)[..., None] + 1e-6
        o = num / den
        return (lambda x, *d: x.permute(*d))(o, 0, 2, 1, 3).reshape(B, S, D) @ wo

    def _B_ref(x, w1, w2):
        h = torch.einsum("bsd,df->bsf", x, w1)
        h = _silu(h)
        out = torch.einsum("bsf,fd->bsd", h, w2)
        return out

    x = A_x
    xn = _layernorm(x, axis=-1)
    s = _A_ref(xn, A_wqkv, A_w_phi, A_wo)
    g = _silu(_B_ref(xn, B_w1, B_w2))
    return x + s * g
```

```asm
; @launch grid=(256,1,1) block=(256,1,1) lds=163840
.amdgcn_target "amdgcn-amd-amdhsa--gfx950"
.text
.globl recurrent_scan__linear_kernel_hedgehog__dense_activation_silu__prompt_kernel
.p2align 8
.type recurrent_scan__linear_kernel_hedgehog__dense_activation_silu__prompt_kernel,@function
recurrent_scan__linear_kernel_hedgehog__dense_activation_silu__prompt_kernel:
    s_cmp_ge_u32 s2, 256
    s_cbranch_scc1 Lend
    s_load_dwordx2 s[4:5], s[0:1], 0
    s_load_dwordx2 s[8:9], s[0:1], 8
    s_load_dwordx2 s[12:13], s[0:1], 40
    s_load_dwordx2 s[16:17], s[0:1], 64
    s_load_dwordx2 s[20:21], s[0:1], 72
    s_load_dwordx2 s[24:25], s[0:1], 16
    s_load_dwordx2 s[28:29], s[0:1], 48
    s_load_dwordx2 s[32:33], s[0:1], 24
    s_load_dwordx2 s[36:37], s[0:1], 56
    s_memrealtime s[40:41]
    s_getpc_b64 s[42:43]
Lcode_pc:
    s_lshr_b32 s3, s2, 3
    s_lshl_b32 s45, s3, 12
    v_lshlrev_b32 v3, 4, v0
    v_add_u32 v3, s45, v3
    s_mov_b32 s46, Lcode_end-Lcode_pc-16
    v_min_u32 v3, s46, v3
    global_load_dwordx4 v[4:7], v3, s[42:43]
    v_and_b32 v1, 63, v0
    v_lshrrev_b32 v8, 6, v0
    v_lshlrev_b32 v2, 4, v1
    v_readfirstlane_b32 s44, v8
    s_bfe_u32 s45, s2, 0x20001
    s_lshr_b32 s46, s3, 3
    s_lshl2_add_u32 s49, s45, s46
    s_lshr_b32 s46, s3, 2
    s_lshl3_add_u32 s51, s45, s46
    s_and_b32 s45, s2, 1
    s_and_b32 s46, s3, 7
    s_lshl3_add_u32 s50, s45, s46
    s_and_b32 s46, s3, 3
    s_lshl2_add_u32 s52, s45, s46
    v_lshrrev_b32 v21, 5, v1
    v_and_b32 v22, 31, v1
    s_and_b32 s53, s2, 7
    v_lshrrev_b32 v8, 3, v1
    v_and_b32 v9, 7, v1
    s_mul_i32 s45, s53, 307200
    s_lshl_b32 s46, s3, 7
    s_add_u32 s45, s45, s46
    s_cmp_lt_u32 s2, 240
    s_cselect_b32 s45, s45, 0x80000000
    v_mul_u32_u24 v23, 3840, v8
    v_lshl_add_u32 v23, v9, 4, v23
    v_add_u32 v23, s45, v23
    v_lshrrev_b32 v10, 1, v8
    v_xor_b32 v10, v10, v9
    s_lshl2_add_u32 s45, s49, s44
    s_mul_i32 s45, s45, 40960
    v_mul_u32_u24 v24, 1280, v8
    v_lshl_add_u32 v24, v10, 4, v24
    v_add_u32 v24, s45, v24
    v_xor_b32 v25, 64, v24
    v_add_u32 v25, 10240, v25
    v_add_u32 v26, 20480, v24
    v_add_u32 v27, 20480, v25
    s_mul_i32 s45, s44, 49152
    s_mul_i32 s46, s50, 192
    s_add_u32 s45, s45, s46
    v_add_u32 v8, 0, v1
    v_mul_u32_u24 v9, 43691, v8
    v_lshrrev_b32 v9, 19, v9
    v_mul_u32_u24 v9, 2880, v9
    v_lshl_add_u32 v9, v8, 4, v9
    v_add_u32 v28, s45, v9
    v_add_u32 v8, 64, v1
    v_mul_u32_u24 v9, 43691, v8
    v_lshrrev_b32 v9, 19, v9
    v_mul_u32_u24 v9, 2880, v9
    v_lshl_add_u32 v9, v8, 4, v9
    v_add_u32 v29, s45, v9
    v_add_u32 v8, 128, v1
    v_mul_u32_u24 v9, 43691, v8
    v_lshrrev_b32 v9, 19, v9
    v_mul_u32_u24 v9, 2880, v9
    v_lshl_add_u32 v9, v8, 4, v9
    v_add_u32 v30, s45, v9
    s_lshl4_add_u32 s54, s49, s50
    s_lshl2_add_u32 s54, s54, s44
    s_lshl_b32 s54, s54, 1
    s_mul_i32 s45, s54, 1280
    v_mul_u32_u24 v31, 1280, v21
    v_mad_u32_u24 v31, v22, 40, v31
    s_lshl_b32 s46, s2, 10
    v_add_u32 v10, s46, v0
    v_lshlrev_b32 v10, 8, v10
    s_lshl_b32 s55, s44, 10
    s_mul_i32 s56, s44, 30720
    s_lshl_b32 s57, s44, 12
    s_mul_i32 s58, s44, 3072
    s_waitcnt lgkmcnt(0)
    s_and_b32 s17, s17, 0xffff
    s_mov_b32 s18, 0x100
    s_mov_b32 s19, 0x20000
    s_or_b32 s40, s40, 1
    v_mov_b32 v9, s40
    s_and_b32 s9, s9, 0xffff
    s_mov_b32 s10, 0x258000
    s_mov_b32 s11, 0x20000
    buffer_store_dword v9, v10, s[16:19], 0 offen sc1
    s_and_b32 s5, s5, 0xffff
    s_mov_b32 s6, 0x280000
    s_mov_b32 s7, 0x20000
    s_add_u32 m0, s55, 143360
    s_nop 0
    buffer_load_dwordx4 v23, s[8:11], s56 offen lds
    s_add_u32 s56, s56, 122880
    s_add_u32 m0, s55, 147456
    s_nop 0
    buffer_load_dwordx4 v23, s[8:11], s56 offen lds
    s_add_u32 s56, s56, 122880
    s_add_u32 m0, s55, 151552
    s_cmp_lt_u32 s44, 2
    s_cselect_b32 s56, s56, 0x40000000
    buffer_load_dwordx4 v23, s[8:11], s56 offen lds
    buffer_load_dwordx4 v[96:99], v31, s[4:7], s45 offen
    buffer_load_dwordx4 v[100:103], v31, s[4:7], s45 offen offset:16
    buffer_load_dwordx2 v[104:105], v31, s[4:7], s45 offen offset:32
    s_and_b32 s13, s13, 0xffff
    s_mov_b32 s14, 0x1e0000
    s_mov_b32 s15, 0x20000
    s_movk_i32 s40, 0
    s_add_u32 m0, s57, 0
    s_nop 0
    buffer_load_dwordx4 v24, s[4:7], s40 offen lds
    s_add_u32 m0, s57, 1024
    s_nop 0
    buffer_load_dwordx4 v25, s[4:7], s40 offen lds
    s_add_u32 m0, s57, 2048
    s_nop 0
    buffer_load_dwordx4 v26, s[4:7], s40 offen lds
    s_add_u32 m0, s57, 3072
    s_nop 0
    buffer_load_dwordx4 v27, s[4:7], s40 offen lds
    s_mov_b32 s40, 0
    s_add_u32 m0, s58, 16384
    s_nop 0
    buffer_load_dwordx4 v28, s[12:15], s40 offen lds
    s_add_u32 m0, s58, 17408
    s_nop 0
    buffer_load_dwordx4 v29, s[12:15], s40 offen lds
    s_add_u32 m0, s58, 18432
    s_nop 0
    buffer_load_dwordx4 v30, s[12:15], s40 offen lds
    s_movk_i32 s40, 128
    s_add_u32 m0, s57, 28672
    s_and_b32 s21, s21, 0xffff
    s_mov_b32 s22, 0xf40400
    s_mov_b32 s23, 0x20000
    s_and_b32 s25, s25, 0xffff
    s_mov_b32 s26, 0x6400
    s_mov_b32 s27, 0x20000
    s_and_b32 s29, s29, 0xffff
    s_mov_b32 s30, 0x1e0000
    s_mov_b32 s31, 0x20000
    s_and_b32 s33, s33, 0xffff
    s_mov_b32 s34, 0xc8000
    s_mov_b32 s35, 0x20000
    s_and_b32 s37, s37, 0xffff
    s_mov_b32 s38, 0x280000
    s_mov_b32 s39, 0x20000
    v_lshrrev_b32 v8, 4, v0
    v_and_b32 v9, 15, v0
    s_bfe_u32 s45, s2, 0x20001
    s_lshl_b32 s45, s45, 5
    s_add_u32 s45, s45, s3
    s_mul_i32 s45, s45, 20480
    v_mul_u32_u24 v106, 1280, v8
    v_min_u32 v10, 5, v9
    v_lshl_add_u32 v106, v10, 7, v106
    v_add_u32 v106, s45, v106
    s_mul_i32 s45, s3, 36864
    s_bitcmp1_b32 s2, 0
    s_cselect_b32 s46, 1536, 0
    s_add_u32 s45, s45, 786432
    s_add_u32 s45, s45, s46
    v_min_u32 v8, 11, v8
    v_min_u32 v9, 11, v9
    v_mul_u32_u24 v107, 3072, v8
    v_lshl_add_u32 v107, v9, 7, v107
    v_add_u32 v107, s45, v107
    s_mul_i32 s45, s50, 1600
    v_lshlrev_b32 v8, 2, v0
    buffer_load_dword v32, v8, s[24:27], s45 offen
    buffer_load_dword v33, v8, s[24:27], s45 offen offset:800
    v_mov_b32 v148, 0
    v_mov_b32 v149, 0
    v_mov_b32 v150, 0
    v_mov_b32 v151, 0
    v_lshlrev_b32 v8, 4, v0
    v_add_u32 v8, 155648, v8
    ds_write_b128 v8, v[148:151]
    v_lshrrev_b32 v14, 4, v1
    v_bfe_u32 v15, v1, 2, 2
    buffer_load_dwordx4 v24, s[4:7], s40 offen lds
    s_add_u32 m0, s57, 29696
    v_and_b32 v20, 3, v1
    s_mov_b32 s41, 0x3f803f80
    v_xor_b32 v8, v14, v15
    v_and_b32 v8, 1, v8
    v_cmp_eq_u32 vcc, 0, v8
    v_mov_b32 v9, s41
    s_nop 0
    v_cndmask_b32 v36, 0, v9, vcc
    v_cndmask_b32 v37, 0, v9, vcc
    v_cndmask_b32 v38, 0, v9, vcc
    v_cndmask_b32 v39, 0, v9, vcc
    s_mul_i32 s59, s3, 205
    s_lshr_b32 s59, s59, 11
    s_mul_i32 s45, s59, 10
    s_sub_u32 s45, s3, s45
    s_lshl_b32 s45, s45, 6
    s_lshl4_add_u32 s45, s44, s45
    buffer_load_dwordx4 v25, s[4:7], s40 offen lds
    s_add_u32 m0, s57, 30720
    s_mul_i32 s46, s59, 40
    s_sub_u32 s46, s46, 40
    s_cmp_eq_u32 s59, 0
    s_cselect_b32 s46, 80, s46
    v_and_b32 v8, 15, v1
    v_add_u32 v8, s45, v8
    v_mul_u32_u24 v9, 1639, v8
    v_lshrrev_b32 v9, 16, v9
    v_mul_u32_u24 v10, 40, v9
    v_sub_u32 v8, v8, v10
    v_add_u32 v8, s46, v8
    v_mul_u32_u24 v9, 167936, v9
    v_lshrrev_b32 v10, 5, v8
    v_mul_u32_u24 v10, 41984, v10
    v_add_u32 v9, v9, v10
    buffer_load_dwordx4 v26, s[4:7], s40 offen lds
    s_add_u32 m0, s57, 31744
    v_and_b32 v8, 31, v8
    v_lshl_add_u32 v9, v8, 4, v9
    s_cmp_lt_u32 s2, 240
    s_cselect_b32 s45, 0, 0x80000000
    v_add_u32 v9, s45, v9
    s_lshr_b32 s45, s53, 2
    s_lshl_b32 s45, s45, 9
    s_and_b32 s46, s53, 3
    s_lshl2_add_u32 s45, s46, s45
    s_add_u32 s45, s45, 40960
    v_add_u32 v35, s45, v9
    v_cmp_gt_u32 vcc, 16, v1
    v_mov_b32 v10, 0x80000000
    s_nop 0
    v_cndmask_b32 v35, v10, v35, vcc
    s_mul_i32 s45, s53, 5120
    v_and_b32 v8, 1, v14
    buffer_load_dwordx4 v27, s[4:7], s40 offen lds
    s_mov_b32 s40, 196608
    s_add_u32 m0, s58, 45056
    v_lshl_add_u32 v9, v8, 9, v9
    v_lshl_add_u32 v9, v21, 10, v9
    v_add_u32 v23, s45, v9
    v_cmp_gt_u32 vcc, 32, v1
    v_add_u32 v34, 4096, v23
    s_nop 0
    v_cndmask_b32 v34, v10, v34, vcc
    v_lshl_add_u32 v8, v14, 3, v15
    v_lshlrev_b32 v8, 7, v8
    v_lshl_add_u32 v8, v20, 3, v8
    s_lshl_b32 s45, s44, 5
    s_add_u32 s45, s45, 143360
    v_add_u32 v40, s45, v8
    v_mul_u32_u24 v8, 6554, v0
    v_lshrrev_b32 v8, 16, v8
    buffer_load_dwordx4 v28, s[12:15], s40 offen lds
    s_add_u32 m0, s58, 46080
    v_mul_u32_u24 v9, 10, v8
    v_sub_u32 v9, v0, v9
    v_cmp_le_u32 vcc, 5, v9
    s_nop 1
    v_cndmask_b32 v10, 0, 1, vcc
    v_lshlrev_b32 v8, 6, v8
    v_lshl_add_u32 v8, v10, 3, v8
    v_mul_u32_u24 v10, 5, v10
    v_sub_u32 v9, v9, v10
    v_lshrrev_b32 v10, 1, v9
    v_lshl_add_u32 v8, v10, 4, v8
    v_and_b32 v9, 1, v9
    v_lshl_add_u32 v8, v9, 2, v8
    v_add_u32 v8, 155648, v8
    v_cmp_gt_u32 vcc, 200, v0
    v_mov_b32 v9, 158976
    s_nop 0
    v_cndmask_b32 v42, v9, v8, vcc
    v_mov_b32 v9, 161280
    v_cndmask_b32 v43, v9, v8, vcc
    v_bfe_u32 v8, v1, 1, 3
    v_xor_b32 v8, v8, v21
    v_lshlrev_b32 v8, 4, v8
    v_lshl_add_u32 v8, v22, 7, v8
    buffer_load_dwordx4 v29, s[12:15], s40 offen lds
    s_add_u32 m0, s58, 47104
    v_add_u32 v68, s57, v8
    v_xor_b32 v69, 32, v68
    v_xor_b32 v70, 64, v68
    v_xor_b32 v71, 96, v68
    v_lshl_add_u32 v8, v21, 3, v15
    v_mul_u32_u24 v8, 192, v8
    v_and_b32 v9, 1, v14
    v_lshl_add_u32 v8, v9, 5, v8
    v_lshl_add_u32 v8, v20, 3, v8
    v_add_u32 v44, 16384, v8
    v_add_u32 v48, s58, v44
    v_add_u32 v72, 57344, v68
    v_add_u32 v73, 57344, v69
    v_add_u32 v74, 57344, v70
    v_add_u32 v75, 57344, v71
    v_add_u32 v45, 57344, v44
    v_add_u32 v49, 57344, v48
    v_add_u32 v76, 114688, v68
    v_add_u32 v77, 114688, v69
    v_add_u32 v78, 114688, v70
    v_add_u32 v79, 114688, v71
    buffer_load_dwordx4 v30, s[12:15], s40 offen lds
    s_movk_i32 s40, 256
    s_add_u32 m0, s57, 57344
    v_add_u32 v46, 114688, v44
    v_add_u32 v50, 114688, v48
    s_waitcnt vmcnt(19)
    s_waitcnt lgkmcnt(0)
    s_barrier
    ds_read_b64_tr_b16 v[148:149], v40 offset:0
    ds_read_b64_tr_b16 v[150:151], v40 offset:512
    ds_read_b64_tr_b16 v[152:153], v40 offset:4096
    ds_read_b64_tr_b16 v[154:155], v40 offset:4608
    ds_read_b64_tr_b16 v[156:157], v40 offset:8192
    ds_read_b64_tr_b16 v[158:159], v40 offset:8704
    v_mov_b32 v55, 0
    buffer_load_dword v11, v55, s[16:19], 0 offen sc1
    buffer_load_dwordx4 v24, s[4:7], s40 offen lds
    s_add_u32 m0, s57, 58368
    s_nop 0
    buffer_load_dwordx4 v25, s[4:7], s40 offen lds
    s_add_u32 m0, s57, 59392
    s_nop 0
    buffer_load_dwordx4 v26, s[4:7], s40 offen lds
    s_add_u32 m0, s57, 60416
    s_nop 0
    buffer_load_dwordx4 v27, s[4:7], s40 offen lds
    s_mov_b32 s40, 393216
    s_add_u32 m0, s58, 73728
    s_waitcnt vmcnt(13)
    ds_write_b32 v43, v32
    s_waitcnt vmcnt(12)
    ds_write_b32 v42, v33 offset:2304
    s_waitcnt lgkmcnt(6)
    buffer_store_dwordx4 v[148:151], v23, s[20:23], 0 offen offset:0 sc1
    s_waitcnt lgkmcnt(4)
    buffer_store_dwordx4 v[152:155], v23, s[20:23], 0 offen offset:2048 sc1
    s_waitcnt lgkmcnt(2)
    buffer_store_dwordx4 v[156:159], v34, s[20:23], 0 offen offset:0 sc1
    v_dot2_f32_bf16 v8, v148, s41, 0
    v_dot2_f32_bf16 v9, v149, s41, 0
    v_dot2_f32_bf16 v8, v150, s41, v8
    v_dot2_f32_bf16 v9, v151, s41, v9
    v_dot2_f32_bf16 v8, v152, s41, v8
    v_dot2_f32_bf16 v9, v153, s41, v9
    v_dot2_f32_bf16 v8, v154, s41, v8
    v_dot2_f32_bf16 v9, v155, s41, v9
    v_dot2_f32_bf16 v8, v156, s41, v8
    v_dot2_f32_bf16 v9, v157, s41, v9
    v_dot2_f32_bf16 v8, v158, s41, v8
    v_dot2_f32_bf16 v9, v159, s41, v9
    s_nop 2
    v_add_f32 v9, v8, v9
    v_mov_b32 v10, v9
    s_nop 1
    v_permlane32_swap_b32 v9, v10
    v_add_f32 v9, v9, v10
    v_mov_b32 v10, v9
    s_nop 1
    v_permlane16_swap_b32 v9, v10
    v_add_f32 v9, v9, v10
    v_cvt_pk_bf16_f32 v10, v9, v9
    v_lshlrev_b32 v10, 16, v10
    v_sub_f32 v10, v9, v10
    v_cvt_pk_bf16_f32 v9, v9, v10
    buffer_store_dword v9, v35, s[20:23], 0 offen sc1
    v_dot2_f32_bf16 v8, v96, s41, 0
    v_dot2_f32_bf16 v9, v97, s41, 0
    v_dot2_f32_bf16 v8, v98, s41, v8
    v_dot2_f32_bf16 v9, v99, s41, v9
    v_dot2_f32_bf16 v8, v100, s41, v8
    v_dot2_f32_bf16 v9, v101, s41, v9
    v_dot2_f32_bf16 v8, v102, s41, v8
    v_dot2_f32_bf16 v9, v103, s41, v9
    v_dot2_f32_bf16 v8, v104, s41, v8
    v_dot2_f32_bf16 v9, v105, s41, v9
    v_lshlrev_b32 v184, 16, v96
    v_and_b32 v185, 0xffff0000, v96
    v_lshlrev_b32 v186, 16, v97
    buffer_load_dwordx4 v28, s[12:15], s40 offen lds
    s_add_u32 m0, s58, 74752
    v_and_b32 v187, 0xffff0000, v97
    v_lshlrev_b32 v188, 16, v98
    v_and_b32 v189, 0xffff0000, v98
    v_lshlrev_b32 v190, 16, v99
    v_and_b32 v191, 0xffff0000, v99
    v_lshlrev_b32 v192, 16, v100
    v_and_b32 v193, 0xffff0000, v100
    v_lshlrev_b32 v194, 16, v101
    v_and_b32 v195, 0xffff0000, v101
    v_lshlrev_b32 v196, 16, v102
    v_and_b32 v197, 0xffff0000, v102
    v_lshlrev_b32 v198, 16, v103
    v_and_b32 v199, 0xffff0000, v103
    v_lshlrev_b32 v200, 16, v104
    v_and_b32 v201, 0xffff0000, v104
    v_lshlrev_b32 v202, 16, v105
    v_and_b32 v203, 0xffff0000, v105
    v_add_f32 v8, v8, v9
    s_nop 1
    v_add_f32_dpp v8, v8, v8 row_ror:8 row_mask:0xf bank_mask:0xf
    s_nop 1
    v_add_f32_dpp v8, v8, v8 row_ror:4 row_mask:0xf bank_mask:0xf
    s_nop 1
    v_add_f32_dpp v8, v8, v8 row_ror:2 row_mask:0xf bank_mask:0xf
    buffer_load_dwordx4 v29, s[12:15], s40 offen lds
    s_add_u32 m0, s58, 75776
    v_add_f32_dpp v8, v8, v8 row_ror:1 row_mask:0xf bank_mask:0xf
    v_mov_b32 v9, v8
    s_nop 1
    v_permlane16_swap_b32 v8, v9
    v_add_f32 v8, v8, v9
    v_mul_f32 v8, 0x3acccccd, v8
    v_sub_f32 v184, v184, v8
    v_sub_f32 v185, v185, v8
    v_sub_f32 v186, v186, v8
    v_sub_f32 v187, v187, v8
    v_sub_f32 v188, v188, v8
    v_sub_f32 v189, v189, v8
    v_sub_f32 v190, v190, v8
    v_sub_f32 v191, v191, v8
    v_sub_f32 v192, v192, v8
    v_sub_f32 v193, v193, v8
    v_sub_f32 v194, v194, v8
    v_sub_f32 v195, v195, v8
    v_sub_f32 v196, v196, v8
    v_sub_f32 v197, v197, v8
    v_sub_f32 v198, v198, v8
    v_sub_f32 v199, v199, v8
    v_sub_f32 v200, v200, v8
    buffer_load_dwordx4 v30, s[12:15], s40 offen lds
    v_sub_f32 v201, v201, v8
    v_sub_f32 v202, v202, v8
    v_sub_f32 v203, v203, v8
    v_mul_f32 v9, v184, v184
    v_mul_f32 v10, v185, v185
    v_fmac_f32 v9, v186, v186
    v_fmac_f32 v10, v187, v187
    v_fmac_f32 v9, v188, v188
    v_fmac_f32 v10, v189, v189
    v_fmac_f32 v9, v190, v190
    v_fmac_f32 v10, v191, v191
    v_fmac_f32 v9, v192, v192
    v_fmac_f32 v10, v193, v193
    v_fmac_f32 v9, v194, v194
    v_fmac_f32 v10, v195, v195
    v_fmac_f32 v9, v196, v196
    v_fmac_f32 v10, v197, v197
    v_fmac_f32 v9, v198, v198
    v_fmac_f32 v10, v199, v199
    v_fmac_f32 v9, v200, v200
    v_fmac_f32 v10, v201, v201
    v_fmac_f32 v9, v202, v202
    buffer_load_dword v108, v106, s[4:7], 0 offen offset:512
    v_fmac_f32 v10, v203, v203
    v_add_f32 v9, v9, v10
    s_nop 1
    v_add_f32_dpp v9, v9, v9 row_ror:8 row_mask:0xf bank_mask:0xf
    s_nop 1
    v_add_f32_dpp v9, v9, v9 row_ror:4 row_mask:0xf bank_mask:0xf
    s_nop 1
    v_add_f32_dpp v9, v9, v9 row_ror:2 row_mask:0xf bank_mask:0xf
    s_nop 1
    v_add_f32_dpp v9, v9, v9 row_ror:1 row_mask:0xf bank_mask:0xf
    v_mov_b32 v10, v9
    s_nop 1
    v_permlane16_swap_b32 v9, v10
    v_add_f32 v9, v9, v10
    v_mul_f32 v9, 0x3acccccd, v9
    v_cvt_pk_bf16_f32 v9, v9, v9
    v_lshlrev_b32 v9, 16, v9
    v_add_f32 v9, 0x3727c5ac, v9
    buffer_load_dword v109, v107, s[12:15], 0 offen
    s_movk_i32 s40, 384
    s_add_u32 m0, s57, 86016
    v_cvt_pk_bf16_f32 v9, v9, v9
    v_lshlrev_b32 v9, 16, v9
    v_sqrt_f32 v9, v9
    s_nop 0
    v_cvt_pk_bf16_f32 v52, -v8, v9
    s_lshl_b32 s45, s54, 3
    s_add_u32 s45, s45, 15320064
    v_lshlrev_b32 v10, 24, v22
    v_lshl_add_u32 v10, v21, 3, v10
    v_add_u32 v54, s45, v10
    buffer_load_dwordx4 v24, s[4:7], s40 offen lds
    s_add_u32 m0, s57, 87040
    s_nop 0
    buffer_load_dwordx4 v25, s[4:7], s40 offen lds
    s_add_u32 m0, s57, 88064
    s_nop 0
    buffer_load_dwordx4 v26, s[4:7], s40 offen lds
    s_add_u32 m0, s57, 89088
    s_nop 0
    buffer_load_dwordx4 v27, s[4:7], s40 offen lds
    s_mov_b32 s40, 589824
    s_add_u32 m0, s58, 102400
    s_nop 0
    buffer_load_dwordx4 v28, s[12:15], s40 offen lds
    s_add_u32 m0, s58, 103424
    s_nop 0
    buffer_load_dwordx4 v29, s[12:15], s40 offen lds
    s_add_u32 m0, s58, 104448
    s_nop 0
    buffer_load_dwordx4 v30, s[12:15], s40 offen lds
    v_lshl_add_u32 v7, v21, 2, v15
    v_lshlrev_b32 v7, 6, v7
    v_and_b32 v23, 1, v14
    v_lshl_add_u32 v7, v23, 5, v7
    v_lshl_add_u32 v7, v20, 3, v7
    v_add_u32 v7, 155648, v7
    s_waitcnt lgkmcnt(0)
    s_barrier
    ds_read_b128 a[0:3], v68 offset:0
    ds_read_b64_tr_b16 v[112:113], v44 offset:0
    ds_read_b64_tr_b16 v[114:115], v44 offset:768
    ds_read_b64_tr_b16 v[116:117], v44 offset:64
    ds_read_b64_tr_b16 v[118:119], v44 offset:832
    ds_read_b64_tr_b16 v[120:121], v44 offset:128
    ds_read_b64_tr_b16 v[122:123], v44 offset:896
    ds_read_b128 a[4:7], v69 offset:0
    ds_read_b64_tr_b16 v[124:125], v44 offset:3072
    ds_read_b64_tr_b16 v[126:127], v44 offset:3840
    ds_read_b64_tr_b16 v[128:129], v44 offset:3136
    ds_read_b64_tr_b16 v[130:131], v44 offset:3904
    ds_read_b64_tr_b16 v[132:133], v44 offset:3200
    ds_read_b64_tr_b16 v[134:135], v44 offset:3968
    s_movk_i32 s40, 512
    s_add_u32 m0, s57, 114688
    s_lshl_b32 s45, s2, 2
    s_add_u32 s45, s45, 15302656
    v_lshlrev_b32 v12, 24, v0
    v_add_u32 v12, s45, v12
    s_mul_i32 s9, s50, 167936
    s_mul_i32 s10, s44, 10240
    s_add_u32 s8, s9, s10
    v_mov_b32 v10, 0x80000000
    v_cmp_gt_u32 vcc, 24, v22
    s_nop 1
    v_cndmask_b32 v31, v10, v2, vcc
    s_mov_b32 s3, 161280
    s_lshl_b32 s41, s44, 8
    s_add_u32 s41, s41, s2
    s_lshr_b32 s53, s41, 3
    s_mul_i32 s11, s44, 5120
    s_cmp_lt_u32 s53, 48
    s_cselect_b32 s24, s28, s32
    s_cselect_b32 s25, s29, s33
    s_cselect_b32 s26, s30, s34
    s_cselect_b32 s27, s31, s35
    s_waitcnt lgkmcnt(7)
    v_mfma_f32_32x32x16_bf16 v[208:223], v[112:115], a[0:3], 0
    ds_read_b128 a[8:11], v70 offset:0
    ds_read_b64_tr_b16 v[136:137], v44 offset:6144
    ds_read_b64_tr_b16 v[138:139], v44 offset:6912
    ds_read_b64_tr_b16 v[160:161], v48 offset:0
    ds_read_b64_tr_b16 v[162:163], v48 offset:768
    buffer_load_dwordx4 v24, s[4:7], s40 offen lds
    v_mfma_f32_32x32x16_bf16 v[224:239], v[116:119], a[0:3], 0
    ds_read_b64_tr_b16 v[140:141], v44 offset:6208
    ds_read_b64_tr_b16 v[142:143], v44 offset:6976
    ds_read_b64_tr_b16 v[144:145], v44 offset:6272
    ds_read_b64_tr_b16 v[146:147], v44 offset:7040
    ds_read_b64_tr_b16 v[164:165], v48 offset:64
    ds_read_b64_tr_b16 v[166:167], v48 offset:832
    v_mfma_f32_32x32x16_bf16 v[240:255], v[120:123], a[0:3], 0
    ds_read_b64_tr_b16 v[168:169], v48 offset:128
    ds_read_b64_tr_b16 v[170:171], v48 offset:896
    s_add_u32 m0, s57, 115712
    s_nop 0
    buffer_load_dwordx4 v25, s[4:7], s40 offen lds
    s_add_u32 m0, s57, 116736
    s_waitcnt lgkmcnt(13)
    v_mfma_f32_32x32x16_bf16 v[208:223], v[124:127], a[4:7], v[208:223]
    ds_read_b128 a[12:15], v71 offset:0
    ds_read_b64_tr_b16 v[112:113], v44 offset:9216
    ds_read_b64_tr_b16 v[114:115], v44 offset:9984
    v_bfe_u32 v60, v1, 3, 2
    v_bfe_u32 v61, v1, 2, 1
    s_sub_u32 s45, s53, 48
    v_mfma_f32_32x32x16_bf16 v[224:239], v[128:131], a[4:7], v[224:239]
    ds_read_b64_tr_b16 v[116:117], v44 offset:9280
    ds_read_b64_tr_b16 v[118:119], v44 offset:10048
    ds_read_b64_tr_b16 v[120:121], v44 offset:9344
    ds_read_b64_tr_b16 v[122:123], v44 offset:10112
    buffer_load_dwordx4 v26, s[4:7], s40 offen lds
    s_add_u32 m0, s57, 117760
    v_mfma_f32_32x32x16_bf16 v[240:255], v[132:135], a[4:7], v[240:255]
    s_lshl_b32 s45, s45, 2
    s_and_b32 s45, s45, 0xff
    v_add_u32 v62, s45, v60
    v_mul_u32_u24 v63, 205, v62
    v_lshrrev_b32 v63, 10, v63
    s_waitcnt lgkmcnt(7)
    v_mfma_f32_16x16x32_bf16 v[172:175], v[36:39], v[160:163], 0
    buffer_load_dwordx4 v27, s[4:7], s40 offen lds
    s_mov_b32 s40, 786432
    v_mfma_f32_16x16x32_bf16 v[176:179], v[36:39], v[164:167], 0
    s_add_u32 m0, s58, 131072
    v_mul_u32_u24 v64, 5, v63
    v_mfma_f32_16x16x32_bf16 v[180:183], v[36:39], v[168:171], 0
    v_sub_u32 v62, v62, v64
    v_lshrrev_b32 v64, 1, v62
    v_mfma_f32_32x32x16_bf16 v[208:223], v[136:139], a[8:11], v[208:223]
    s_waitcnt vmcnt(25)
    s_barrier
    ds_read_b128 a[16:19], v68 offset:28672
    ds_read_b64_tr_b16 v[124:125], v44 offset:28672
    ds_read_b64_tr_b16 v[126:127], v44 offset:29440
    ds_read_b64_tr_b16 v[80:81], v7 offset:0
    ds_read_b64_tr_b16 v[82:83], v7 offset:512
    ds_read_b64_tr_b16 v[84:85], v7 offset:1024
    ds_read_b64_tr_b16 v[86:87], v7 offset:1536
    v_mfma_f32_32x32x16_bf16 v[224:239], v[140:143], a[8:11], v[224:239]
    ds_read_b64_tr_b16 v[128:129], v44 offset:28736
    ds_read_b64_tr_b16 v[130:131], v44 offset:29504
    ds_read_b64_tr_b16 v[132:133], v44 offset:28800
    ds_read_b64_tr_b16 v[134:135], v44 offset:29568
    ds_read_b64_tr_b16 v[88:89], v7 offset:2048
    ds_read_b64_tr_b16 v[90:91], v7 offset:2560
    ds_read_b64_tr_b16 v[92:93], v7 offset:3072
    ds_read_b64_tr_b16 v[94:95], v7 offset:3584
    v_mfma_f32_32x32x16_bf16 v[240:255], v[144:147], a[8:11], v[240:255]
    buffer_load_dwordx4 v28, s[12:15], s40 offen lds
    s_add_u32 m0, s58, 132096
    v_mul_u32_u24 v64, 20, v64
    v_and_b32 v8, 1, v62
    v_lshl_add_u32 v64, v8, 3, v64
    s_waitcnt lgkmcnt(15)
    v_mfma_f32_32x32x16_bf16 v[208:223], v[112:115], a[12:15], v[208:223]
    ds_read_b128 a[20:23], v69 offset:28672
    ds_read_b64_tr_b16 v[136:137], v44 offset:31744
    ds_read_b64_tr_b16 v[138:139], v44 offset:32512
    ds_read_b64_tr_b16 v[160:161], v48 offset:28672
    ds_read_b64_tr_b16 v[162:163], v48 offset:29440
    buffer_load_dwordx4 v29, s[12:15], s40 offen lds
    v_mfma_f32_32x32x16_bf16 v[224:239], v[116:119], a[12:15], v[224:239]
    ds_read_b64_tr_b16 v[140:141], v44 offset:31808
    ds_read_b64_tr_b16 v[142:143], v44 offset:32576
    ds_read_b64_tr_b16 v[144:145], v44 offset:31872
    ds_read_b64_tr_b16 v[146:147], v44 offset:32640
    ds_read_b64_tr_b16 v[164:165], v48 offset:28736
    ds_read_b64_tr_b16 v[166:167], v48 offset:29504
    v_mfma_f32_32x32x16_bf16 v[240:255], v[120:123], a[12:15], v[240:255]
    ds_read_b64_tr_b16 v[168:169], v48 offset:28800
    ds_read_b64_tr_b16 v[170:171], v48 offset:29568
    s_add_u32 m0, s58, 133120
    v_lshl_add_u32 v64, v61, 2, v64
    v_mad_u32_u24 v8, v61, 20, 16
    s_waitcnt lgkmcnt(15)
    v_mfma_f32_32x32x16_bf16 v[208:223], v[124:127], a[16:19], v[208:223]
    ds_read_b128 a[24:27], v70 offset:28672
    ds_read_b64_tr_b16 v[112:113], v44 offset:34816
    ds_read_b64_tr_b16 v[114:115], v44 offset:35584
    buffer_load_dwordx4 v30, s[12:15], s40 offen lds
    v_cmp_eq_u32 vcc, 4, v62
    s_nop 1
    v_cndmask_b32 v64, v64, v8, vcc
    v_mfma_f32_32x32x16_bf16 v[224:239], v[128:131], a[16:19], v[224:239]
    ds_read_b64_tr_b16 v[116:117], v44 offset:34880
    ds_read_b64_tr_b16 v[118:119], v44 offset:35648
    ds_read_b64_tr_b16 v[120:121], v44 offset:34944
    ds_read_b64_tr_b16 v[122:123], v44 offset:35712
    v_mad_u32_u24 v64, v63, 40, v64
    v_lshrrev_b32 v62, 1, v60
    v_mfma_f32_32x32x16_bf16 v[240:255], v[132:135], a[16:19], v[240:255]
    v_add_u32 v7, 41984, v2
    v_add_u32 v23, 83968, v2
    v_and_b32 v60, 1, v60
    v_lshlrev_b32 v62, 4, v62
    v_lshl_add_u32 v62, v60, 2, v62
    s_waitcnt lgkmcnt(11)
    v_mfma_f32_32x32x16_bf16 v[208:223], v[136:139], a[20:23], v[208:223]
    ds_read_b128 a[28:31], v71 offset:28672
    ds_read_b64_tr_b16 v[124:125], v44 offset:37888
    ds_read_b64_tr_b16 v[126:127], v44 offset:38656
    v_lshl_add_u32 v62, v61, 3, v62
    s_lshl_b32 s45, s53, 5
    v_add_u32 v62, s45, v62
    v_mfma_f32_32x32x16_bf16 v[224:239], v[140:143], a[20:23], v[224:239]
    ds_read_b64_tr_b16 v[128:129], v44 offset:37952
    ds_read_b64_tr_b16 v[130:131], v44 offset:38720
    ds_read_b64_tr_b16 v[132:133], v44 offset:38016
    ds_read_b64_tr_b16 v[134:135], v44 offset:38784
    s_cmp_lt_u32 s53, 48
    s_cselect_b64 vcc, -1, 0
    v_mfma_f32_32x32x16_bf16 v[240:255], v[144:147], a[20:23], v[240:255]
    v_cndmask_b32 v62, v64, v62, vcc
    v_add_u32 v62, v62, v20
    s_and_b32 s45, s41, 7
    s_mul_i32 s45, s45, 160
    s_cmp_lt_u32 s41, 544
    s_cselect_b32 s45, s45, 0x80000000
    s_waitcnt lgkmcnt(14)
    v_mfma_f32_16x16x32_bf16 v[172:175], v[36:39], v[160:163], v[172:175]
    v_mul_u32_u24 v9, 1280, v62
    v_add_u32 v9, s45, v9
    v_mfma_f32_16x16x32_bf16 v[176:179], v[36:39], v[164:167], v[176:179]
    v_lshl_add_u32 v111, v21, 7, v9
    buffer_load_dword v111, v111, s[24:27], 0 offen
    v_mfma_f32_16x16x32_bf16 v[180:183], v[36:39], v[168:171], v[180:183]
    v_add_u32 v8, 0, v1
    v_mul_u32_u24 v10, 6554, v8
    s_waitcnt lgkmcnt(7)
    v_mfma_f32_32x32x16_bf16 v[208:223], v[112:115], a[24:27], v[208:223]
    s_waitcnt vmcnt(17)
    s_barrier
    v_readfirstlane_b32 s47, v11
    s_nop 0
    s_cmp_eq_u32 s47, 0
    s_cbranch_scc1 Lnonce
Lnonce_ret:
    v_mov_b32 v53, v11
    buffer_store_dword v11, v12, s[20:23], 0 offen sc1
    buffer_store_dwordx2 v[52:53], v54, s[20:23], 0 offen sc1
    ds_read_b128 a[32:35], v72 offset:0
    ds_read_b64_tr_b16 v[136:137], v45 offset:0
    ds_read_b64_tr_b16 v[138:139], v45 offset:768
    v_mfma_f32_32x32x16_bf16 v[224:239], v[116:119], a[24:27], v[224:239]
    ds_read_b64_tr_b16 v[140:141], v45 offset:64
    ds_read_b64_tr_b16 v[142:143], v45 offset:832
    ds_read_b64_tr_b16 v[144:145], v45 offset:128
    ds_read_b64_tr_b16 v[146:147], v45 offset:896
    s_movk_i32 s40, 640
    s_add_u32 m0, s57, 0
    v_mfma_f32_32x32x16_bf16 v[240:255], v[120:123], a[24:27], v[240:255]
    buffer_load_dwordx4 v24, s[4:7], s40 offen lds
    s_add_u32 m0, s57, 1024
    v_lshrrev_b32 v10, 16, v10
    v_mul_u32_u24 v106, 10, v10
    v_sub_u32 v106, v8, v106
    s_waitcnt lgkmcnt(7)
    v_mfma_f32_32x32x16_bf16 v[208:223], v[124:127], a[28:31], v[208:223]
    ds_read_b128 a[36:39], v73 offset:0
    ds_read_b64_tr_b16 v[112:113], v45 offset:3072
    ds_read_b64_tr_b16 v[114:115], v45 offset:3840
    ds_read_b64_tr_b16 v[160:161], v49 offset:0
    ds_read_b64_tr_b16 v[162:163], v49 offset:768
    buffer_load_dwordx4 v25, s[4:7], s40 offen lds
    v_mfma_f32_32x32x16_bf16 v[224:239], v[128:131], a[28:31], v[224:239]
    ds_read_b64_tr_b16 v[116:117], v45 offset:3136
    ds_read_b64_tr_b16 v[118:119], v45 offset:3904
    ds_read_b64_tr_b16 v[120:121], v45 offset:3200
    ds_read_b64_tr_b16 v[122:123], v45 offset:3968
    ds_read_b64_tr_b16 v[164:165], v49 offset:64
    ds_read_b64_tr_b16 v[166:167], v49 offset:832
    v_mfma_f32_32x32x16_bf16 v[240:255], v[132:135], a[28:31], v[240:255]
    ds_read_b64_tr_b16 v[168:169], v49 offset:128
    ds_read_b64_tr_b16 v[170:171], v49 offset:896
    s_add_u32 m0, s57, 2048
    v_lshlrev_b32 v10, 2, v10
    ds_bpermute_b32 v60, v10, v9
    s_waitcnt lgkmcnt(14)
    v_mfma_f32_32x32x16_bf16 v[208:223], v[136:139], a[32:35], v[208:223]
    ds_read_b128 a[40:43], v74 offset:0
    ds_read_b64_tr_b16 v[124:125], v45 offset:6144
    ds_read_b64_tr_b16 v[126:127], v45 offset:6912
    buffer_load_dwordx4 v26, s[4:7], s40 offen lds
    s_add_u32 m0, s57, 3072
    v_add_u32 v8, 64, v1
    v_mfma_f32_32x32x16_bf16 v[224:239], v[140:143], a[32:35], v[224:239]
    ds_read_b64_tr_b16 v[128:129], v45 offset:6208
    ds_read_b64_tr_b16 v[130:131], v45 offset:6976
    ds_read_b64_tr_b16 v[132:133], v45 offset:6272
    ds_read_b64_tr_b16 v[134:135], v45 offset:7040
    v_mul_u32_u24 v10, 6554, v8
    v_lshrrev_b32 v10, 16, v10
    v_mfma_f32_32x32x16_bf16 v[240:255], v[144:147], a[32:35], v[240:255]
    buffer_load_dwordx4 v27, s[4:7], s40 offen lds
    s_mov_b32 s40, 983040
    s_add_u32 m0, s58, 16384
    v_mul_u32_u24 v107, 10, v10
    v_sub_u32 v107, v8, v107
    s_waitcnt lgkmcnt(12)
    v_mfma_f32_32x32x16_bf16 v[208:223], v[112:115], a[36:39], v[208:223]
    ds_read_b128 a[44:47], v75 offset:0
    ds_read_b64_tr_b16 v[136:137], v45 offset:9216
    ds_read_b64_tr_b16 v[138:139], v45 offset:9984
    v_lshlrev_b32 v10, 2, v10
    ds_bpermute_b32 v61, v10, v9
    v_add_u32 v8, 128, v1
    v_mfma_f32_32x32x16_bf16 v[224:239], v[116:119], a[36:39], v[224:239]
    ds_read_b64_tr_b16 v[140:141], v45 offset:9280
    ds_read_b64_tr_b16 v[142:143], v45 offset:10048
    ds_read_b64_tr_b16 v[144:145], v45 offset:9344
    ds_read_b64_tr_b16 v[146:147], v45 offset:10112
    buffer_load_dwordx4 v28, s[12:15], s40 offen lds
    s_add_u32 m0, s58, 17408
    v_mfma_f32_32x32x16_bf16 v[240:255], v[120:123], a[36:39], v[240:255]
    v_mul_u32_u24 v10, 6554, v8
    v_lshrrev_b32 v10, 16, v10
    s_waitcnt vmcnt(23)
    v_mul_u32_u24 v108, 10, v10
    v_sub_u32 v108, v8, v108
    v_lshlrev_b32 v10, 2, v10
    s_waitcnt lgkmcnt(15)
    v_mfma_f32_16x16x32_bf16 v[172:175], v[36:39], v[160:163], v[172:175]
    ds_bpermute_b32 v62, v10, v9
    v_add_u32 v8, 192, v1
    v_mfma_f32_16x16x32_bf16 v[176:179], v[36:39], v[164:167], v[176:179]
    v_mul_u32_u24 v10, 6554, v8
    v_lshrrev_b32 v10, 16, v10
    v_mfma_f32_16x16x32_bf16 v[180:183], v[36:39], v[168:171], v[180:183]
    s_waitcnt vmcnt(22)
    v_mul_u32_u24 v109, 10, v10
    buffer_load_dwordx4 v29, s[12:15], s40 offen lds
    s_waitcnt lgkmcnt(9)
    v_mfma_f32_32x32x16_bf16 v[208:223], v[124:127], a[40:43], v[208:223]
    s_waitcnt vmcnt(16)
    s_barrier
    ds_read_b128 a[48:51], v72 offset:28672
    ds_read_b64_tr_b16 v[112:113], v45 offset:28672
    ds_read_b64_tr_b16 v[114:115], v45 offset:29440
    s_add_u32 m0, s58, 18432
    v_sub_u32 v109, v8, v109
    v_mfma_f32_32x32x16_bf16 v[224:239], v[128:131], a[40:43], v[224:239]
    ds_read_b64_tr_b16 v[116:117], v45 offset:28736
    ds_read_b64_tr_b16 v[118:119], v45 offset:29504
    ds_read_b64_tr_b16 v[120:121], v45 offset:28800
    ds_read_b64_tr_b16 v[122:123], v45 offset:29568
    v_lshlrev_b32 v10, 2, v10
    ds_bpermute_b32 v63, v10, v9
    v_mfma_f32_32x32x16_bf16 v[240:255], v[132:135], a[40:43], v[240:255]
    v_add_u32 v8, 256, v1
    v_mul_u32_u24 v10, 6554, v8
    v_lshrrev_b32 v10, 16, v10
    v_mul_u32_u24 v110, 10, v10
    buffer_load_dwordx4 v30, s[12:15], s40 offen lds
    s_waitcnt lgkmcnt(9)
    v_mfma_f32_32x32x16_bf16 v[208:223], v[136:139], a[44:47], v[208:223]
    ds_read_b128 a[52:55], v73 offset:28672
    ds_read_b64_tr_b16 v[124:125], v45 offset:31744
    ds_read_b64_tr_b16 v[126:127], v45 offset:32512
    ds_read_b64_tr_b16 v[160:161], v49 offset:28672
    ds_read_b64_tr_b16 v[162:163], v49 offset:29440
    s_movk_i32 s40, 768
    v_mfma_f32_32x32x16_bf16 v[224:239], v[140:143], a[44:47], v[224:239]
    ds_read_b64_tr_b16 v[128:129], v45 offset:31808
    ds_read_b64_tr_b16 v[130:131], v45 offset:32576
    ds_read_b64_tr_b16 v[132:133], v45 offset:31872
    ds_read_b64_tr_b16 v[134:135], v45 offset:32640
    ds_read_b64_tr_b16 v[164:165], v49 offset:28736
    ds_read_b64_tr_b16 v[166:167], v49 offset:29504
    v_mfma_f32_32x32x16_bf16 v[240:255], v[144:147], a[44:47], v[240:255]
    ds_read_b64_tr_b16 v[168:169], v49 offset:28800
    ds_read_b64_tr_b16 v[170:171], v49 offset:29568
    s_add_u32 m0, s57, 28672
    s_nop 0
    buffer_load_dwordx4 v24, s[4:7], s40 offen lds
    s_add_u32 m0, s57, 29696
    s_waitcnt lgkmcnt(14)
    v_mfma_f32_32x32x16_bf16 v[208:223], v[112:115], a[48:51], v[208:223]
    ds_read_b128 a[56:59], v74 offset:28672
    ds_read_b64_tr_b16 v[136:137], v45 offset:34816
    ds_read_b64_tr_b16 v[138:139], v45 offset:35584
    v_sub_u32 v110, v8, v110
    v_lshlrev_b32 v10, 2, v10
    ds_bpermute_b32 v64, v10, v9
    v_mfma_f32_32x32x16_bf16 v[224:239], v[116:119], a[48:51], v[224:239]
    ds_read_b64_tr_b16 v[140:141], v45 offset:34880
    ds_read_b64_tr_b16 v[142:143], v45 offset:35648
    ds_read_b64_tr_b16 v[144:145], v45 offset:34944
    ds_read_b64_tr_b16 v[146:147], v45 offset:35712
    v_lshl_add_u32 v60, v106, 4, v60
    v_lshl_add_u32 v61, v107, 4, v61
    v_mfma_f32_32x32x16_bf16 v[240:255], v[120:123], a[48:51], v[240:255]
    buffer_load_dwordx4 v25, s[4:7], s40 offen lds
    s_add_u32 m0, s57, 30720
    v_lshl_add_u32 v62, v108, 4, v62
    s_waitcnt lgkmcnt(15)
    v_lshl_add_u32 v63, v109, 4, v63
    s_waitcnt lgkmcnt(12)
    v_mfma_f32_32x32x16_bf16 v[208:223], v[124:127], a[52:55], v[208:223]
    ds_read_b128 a[60:63], v75 offset:28672
    ds_read_b64_tr_b16 v[112:113], v45 offset:37888
    ds_read_b64_tr_b16 v[114:115], v45 offset:38656
    v_mfma_f32_32x32x16_bf16 v[224:239], v[128:131], a[52:55], v[224:239]
    ds_read_b64_tr_b16 v[116:117], v45 offset:37952
    ds_read_b64_tr_b16 v[118:119], v45 offset:38720
    ds_read_b64_tr_b16 v[120:121], v45 offset:38016
    ds_read_b64_tr_b16 v[122:123], v45 offset:38784
    buffer_load_dwordx4 v26, s[4:7], s40 offen lds
    s_add_u32 m0, s57, 31744
    v_mfma_f32_32x32x16_bf16 v[240:255], v[132:135], a[52:55], v[240:255]
    s_waitcnt lgkmcnt(11)
    v_lshl_add_u32 v64, v110, 4, v64
    v_min_u32 v13, 59, v1
    v_lshlrev_b32 v13, 4, v13
    v_add_u32 v13, 15302656, v13
    s_lshl2_add_u32 s45, s49, s44
    v_mfma_f32_16x16x32_bf16 v[172:175], v[36:39], v[160:163], v[172:175]
    s_lshl_b32 s45, s45, 8
    buffer_load_dwordx4 v27, s[4:7], s40 offen lds
    v_mfma_f32_16x16x32_bf16 v[176:179], v[36:39], v[164:167], v[176:179]
    s_mov_b32 s40, 1179648
    s_add_u32 m0, s58, 45056
    v_mfma_f32_16x16x32_bf16 v[180:183], v[36:39], v[168:171], v[180:183]
    s_add_u32 s45, s45, 15320064
    v_lshl_add_u32 v34, v22, 3, s45
    s_waitcnt lgkmcnt(7)
    v_mfma_f32_32x32x16_bf16 v[208:223], v[136:139], a[56:59], v[208:223]
    s_waitcnt vmcnt(14)
    s_barrier
    ds_read_b128 a[64:67], v76 offset:0
    ds_read_b64_tr_b16 v[124:125], v46 offset:0
    ds_read_b64_tr_b16 v[126:127], v46 offset:768
    v_lshl_add_u32 v106, v14, 3, v15
    v_mul_u32_u24 v106, 160, v106
    v_mfma_f32_32x32x16_bf16 v[224:239], v[140:143], a[56:59], v[224:239]
    ds_read_b64_tr_b16 v[128:129], v46 offset:64
    ds_read_b64_tr_b16 v[130:131], v46 offset:832
    ds_read_b64_tr_b16 v[132:133], v46 offset:128
    ds_read_b64_tr_b16 v[134:135], v46 offset:896
    buffer_load_dwordx4 v28, s[12:15], s40 offen lds
    s_add_u32 m0, s58, 46080
    v_mfma_f32_32x32x16_bf16 v[240:255], v[144:147], a[56:59], v[240:255]
    v_mad_u32_u24 v106, v20, 40, v106
    s_add_u32 s45, s11, 143360
    v_add_u32 v106, s45, v106
    s_and_b32 s45, s41, 7
    s_mul_i32 s46, s45, 348160
    s_waitcnt lgkmcnt(7)
    v_mfma_f32_32x32x16_bf16 v[208:223], v[112:115], a[60:63], v[208:223]
    ds_read_b128 a[68:71], v77 offset:0
    ds_read_b64_tr_b16 v[136:137], v46 offset:3072
    ds_read_b64_tr_b16 v[138:139], v46 offset:3840
    ds_read_b64_tr_b16 v[160:161], v50 offset:0
    ds_read_b64_tr_b16 v[162:163], v50 offset:768
    s_mul_i32 s55, s53, 5120
    v_mfma_f32_32x32x16_bf16 v[224:239], v[116:119], a[60:63], v[224:239]
    ds_read_b64_tr_b16 v[140:141], v46 offset:3136
    ds_read_b64_tr_b16 v[142:143], v46 offset:3904
    ds_read_b64_tr_b16 v[144:145], v46 offset:3200
    ds_read_b64_tr_b16 v[146:147], v46 offset:3968
    ds_read_b64_tr_b16 v[164:165], v50 offset:64
    ds_read_b64_tr_b16 v[166:167], v50 offset:832
    v_mfma_f32_32x32x16_bf16 v[240:255], v[120:123], a[60:63], v[240:255]
    ds_read_b64_tr_b16 v[168:169], v50 offset:128
    ds_read_b64_tr_b16 v[170:171], v50 offset:896
    buffer_load_dwordx4 v29, s[12:15], s40 offen lds
    s_add_u32 m0, s58, 47104
    s_add_u32 s55, s55, s46
    s_waitcnt lgkmcnt(13)
    v_mfma_f32_32x32x16_bf16 v[208:223], v[124:127], a[64:67], v[208:223]
    ds_read_b128 a[72:75], v78 offset:0
    ds_read_b64_tr_b16 v[112:113], v46 offset:6144
    ds_read_b64_tr_b16 v[114:115], v46 offset:6912
    s_add_u32 s55, s55, 2686976
    s_lshl_b32 s45, s45, 7
    buffer_load_dwordx4 v30, s[12:15], s40 offen lds
    v_mfma_f32_32x32x16_bf16 v[224:239], v[128:131], a[64:67], v[224:239]
    ds_read_b64_tr_b16 v[116:117], v46 offset:6208
    ds_read_b64_tr_b16 v[118:119], v46 offset:6976
    ds_read_b64_tr_b16 v[120:121], v46 offset:6272
    ds_read_b64_tr_b16 v[122:123], v46 offset:7040
    s_movk_i32 s40, 896
    s_add_u32 m0, s57, 57344
    v_mfma_f32_32x32x16_bf16 v[240:255], v[132:135], a[64:67], v[240:255]
    s_add_u32 s45, s45, s53
    s_lshl_b32 s45, s45, 2
    s_add_u32 s45, s45, 15303680
    s_cmp_lt_u32 s41, 544
    s_cselect_b32 s55, s55, 0x40000000
    s_cselect_b32 s45, s45, 0x40000000
    s_waitcnt lgkmcnt(11)
    v_mfma_f32_32x32x16_bf16 v[208:223], v[136:139], a[68:71], v[208:223]
    ds_read_b128 a[76:79], v79 offset:0
    ds_read_b64_tr_b16 v[124:125], v46 offset:9216
    ds_read_b64_tr_b16 v[126:127], v46 offset:9984
    v_lshlrev_b32 v12, 24, v1
    buffer_load_dwordx4 v24, s[4:7], s40 offen lds
    s_add_u32 m0, s57, 58368
    v_mfma_f32_32x32x16_bf16 v[224:239], v[140:143], a[68:71], v[224:239]
    ds_read_b64_tr_b16 v[128:129], v46 offset:9280
    ds_read_b64_tr_b16 v[130:131], v46 offset:10048
    ds_read_b64_tr_b16 v[132:133], v46 offset:9344
    ds_read_b64_tr_b16 v[134:135], v46 offset:10112
    v_add_u32 v12, s45, v12
    v_add_u32 v107, 4096, v2
    v_mfma_f32_32x32x16_bf16 v[240:255], v[144:147], a[68:71], v[240:255]
    buffer_load_dwordx4 v25, s[4:7], s40 offen lds
    s_waitcnt lgkmcnt(14)
    v_mfma_f32_16x16x32_bf16 v[172:175], v[36:39], v[160:163], v[172:175]
    s_add_u32 m0, s57, 59392
    v_mfma_f32_16x16x32_bf16 v[176:179], v[36:39], v[164:167], v[176:179]
    v_mfma_f32_16x16x32_bf16 v[180:183], v[36:39], v[168:171], v[180:183]
    s_waitcnt lgkmcnt(7)
    v_mfma_f32_32x32x16_bf16 v[208:223], v[112:115], a[72:75], v[208:223]
    buffer_load_dwordx4 v26, s[4:7], s40 offen lds
    s_add_u32 m0, s57, 60416
    s_waitcnt vmcnt(10)
    s_barrier
    ds_read_b128 a[80:83], v68 offset:0
    ds_read_b64_tr_b16 v[136:137], v44 offset:0
    ds_read_b64_tr_b16 v[138:139], v44 offset:768
    v_mfma_f32_32x32x16_bf16 v[224:239], v[116:119], a[72:75], v[224:239]
    ds_read_b64_tr_b16 v[140:141], v44 offset:64
    ds_read_b64_tr_b16 v[142:143], v44 offset:832
    ds_read_b64_tr_b16 v[144:145], v44 offset:128
    ds_read_b64_tr_b16 v[146:147], v44 offset:896
    buffer_load_dwordx4 v27, s[4:7], s40 offen lds
    s_mov_b32 s40, 1376256
    v_mfma_f32_32x32x16_bf16 v[240:255], v[120:123], a[72:75], v[240:255]
    s_add_u32 m0, s58, 73728
    s_nop 0
    buffer_load_dwordx4 v28, s[12:15], s40 offen lds
    s_add_u32 m0, s58, 74752
    s_waitcnt lgkmcnt(7)
    v_mfma_f32_32x32x16_bf16 v[208:223], v[124:127], a[76:79], v[208:223]
    ds_read_b128 a[84:87], v69 offset:0
    ds_read_b64_tr_b16 v[112:113], v44 offset:3072
    ds_read_b64_tr_b16 v[114:115], v44 offset:3840
    ds_read_b64_tr_b16 v[160:161], v48 offset:0
    ds_read_b64_tr_b16 v[162:163], v48 offset:768
    v_mfma_f32_32x32x16_bf16 v[224:239], v[128:131], a[76:79], v[224:239]
    ds_read_b64_tr_b16 v[116:117], v44 offset:3136
    ds_read_b64_tr_b16 v[118:119], v44 offset:3904
    ds_read_b64_tr_b16 v[120:121], v44 offset:3200
    ds_read_b64_tr_b16 v[122:123], v44 offset:3968
    ds_read_b64_tr_b16 v[164:165], v48 offset:64
    ds_read_b64_tr_b16 v[166:167], v48 offset:832
    v_mfma_f32_32x32x16_bf16 v[240:255], v[132:135], a[76:79], v[240:255]
    ds_read_b64_tr_b16 v[168:169], v48 offset:128
    ds_read_b64_tr_b16 v[170:171], v48 offset:896
    buffer_load_dwordx4 v29, s[12:15], s40 offen lds
    s_add_u32 m0, s58, 75776
    s_waitcnt lgkmcnt(13)
    v_mfma_f32_32x32x16_bf16 v[208:223], v[136:139], a[80:83], v[208:223]
    ds_read_b128 a[88:91], v70 offset:0
    ds_read_b64_tr_b16 v[124:125], v44 offset:6144
    ds_read_b64_tr_b16 v[126:127], v44 offset:6912
    v_mfma_f32_32x32x16_bf16 v[224:239], v[140:143], a[80:83], v[224:239]
    ds_read_b64_tr_b16 v[128:129], v44 offset:6208
    ds_read_b64_tr_b16 v[130:131], v44 offset:6976
    ds_read_b64_tr_b16 v[132:133], v44 offset:6272
    ds_read_b64_tr_b16 v[134:135], v44 offset:7040
    v_mfma_f32_32x32x16_bf16 v[240:255], v[144:147], a[80:83], v[240:255]
    buffer_load_dwordx4 v30, s[12:15], s40 offen lds
    s_add_u32 m0, s11, 143360
    s_waitcnt lgkmcnt(11)
    v_mfma_f32_32x32x16_bf16 v[208:223], v[112:115], a[84:87], v[208:223]
    ds_read_b128 a[92:95], v71 offset:0
    ds_read_b64_tr_b16 v[136:137], v44 offset:9216
    ds_read_b64_tr_b16 v[138:139], v44 offset:9984
    v_mfma_f32_32x32x16_bf16 v[224:239], v[116:119], a[84:87], v[224:239]
    ds_read_b64_tr_b16 v[140:141], v44 offset:9280
    ds_read_b64_tr_b16 v[142:143], v44 offset:10048
    ds_read_b64_tr_b16 v[144:145], v44 offset:9344
    ds_read_b64_tr_b16 v[146:147], v44 offset:10112
    v_mfma_f32_32x32x16_bf16 v[240:255], v[120:123], a[84:87], v[240:255]
    buffer_load_dwordx4 v60, s[24:27], 0 offen lds
    s_add_u32 m0, s11, 144384
    s_waitcnt lgkmcnt(14)
    v_mfma_f32_16x16x32_bf16 v[172:175], v[36:39], v[160:163], v[172:175]
    v_mfma_f32_16x16x32_bf16 v[176:179], v[36:39], v[164:167], v[176:179]
    v_mfma_f32_16x16x32_bf16 v[180:183], v[36:39], v[168:171], v[180:183]
    buffer_load_dwordx4 v61, s[24:27], 0 offen lds
    s_add_u32 m0, s11, 145408
    s_waitcnt lgkmcnt(7)
    v_mfma_f32_32x32x16_bf16 v[208:223], v[124:127], a[88:91], v[208:223]
    buffer_load_dwordx4 v62, s[24:27], 0 offen lds
    s_add_u32 m0, s11, 146432
    s_nop 0
    buffer_load_dwordx4 v63, s[24:27], 0 offen lds
    s_add_u32 m0, s11, 147456
    s_nop 0
    buffer_load_dwordx4 v64, s[24:27], 0 offen lds
    s_movk_i32 s40, 1024
    s_waitcnt vmcnt(12)
    s_barrier
    ds_read_b128 a[96:99], v68 offset:28672
    ds_read_b64_tr_b16 v[112:113], v44 offset:28672
    ds_read_b64_tr_b16 v[114:115], v44 offset:29440
    v_mfma_f32_32x32x16_bf16 v[224:239], v[128:131], a[88:91], v[224:239]
    ds_read_b64_tr_b16 v[116:117], v44 offset:28736
    ds_read_b64_tr_b16 v[118:119], v44 offset:29504
    ds_read_b64_tr_b16 v[120:121], v44 offset:28800
    ds_read_b64_tr_b16 v[122:123], v44 offset:29568
    s_add_u32 m0, s57, 86016
    s_nop 0
    buffer_load_dwordx4 v24, s[4:7], s40 offen lds
    v_mfma_f32_32x32x16_bf16 v[240:255], v[132:135], a[88:91], v[240:255]
    s_add_u32 m0, s57, 87040
    buffer_load_dwordx4 v[16:19], v13, s[20:23], 0 offen sc1
    buffer_load_dwordx2 v[32:33], v34, s[20:23], 0 offen sc1
    s_waitcnt lgkmcnt(7)
    v_mfma_f32_32x32x16_bf16 v[208:223], v[136:139], a[92:95], v[208:223]
    ds_read_b128 a[100:103], v69 offset:28672
    ds_read_b64_tr_b16 v[124:125], v44 offset:31744
    ds_read_b64_tr_b16 v[126:127], v44 offset:32512
    ds_read_b64_tr_b16 v[160:161], v48 offset:28672
    ds_read_b64_tr_b16 v[162:163], v48 offset:29440
    v_mfma_f32_32x32x16_bf16 v[224:239], v[140:143], a[92:95], v[224:239]
    ds_read_b64_tr_b16 v[128:129], v44 offset:31808
    ds_read_b64_tr_b16 v[130:131], v44 offset:32576
    ds_read_b64_tr_b16 v[132:133], v44 offset:31872
    ds_read_b64_tr_b16 v[134:135], v44 offset:32640
    ds_read_b64_tr_b16 v[164:165], v48 offset:28736
    ds_read_b64_tr_b16 v[166:167], v48 offset:29504
    v_mfma_f32_32x32x16_bf16 v[240:255], v[144:147], a[92:95], v[240:255]
    ds_read_b64_tr_b16 v[168:169], v48 offset:28800
    ds_read_b64_tr_b16 v[170:171], v48 offset:29568
    buffer_load_dwordx4 v25, s[4:7], s40 offen lds
    s_add_u32 m0, s57, 88064
    s_waitcnt lgkmcnt(13)
    v_mfma_f32_32x32x16_bf16 v[208:223], v[112:115], a[96:99], v[208:223]
    ds_read_b128 a[104:107], v70 offset:28672
    ds_read_b64_tr_b16 v[136:137], v44 offset:34816
    ds_read_b64_tr_b16 v[138:139], v44 offset:35584
    v_mfma_f32_32x32x16_bf16 v[224:239], v[116:119], a[96:99], v[224:239]
    ds_read_b64_tr_b16 v[140:141], v44 offset:34880
    ds_read_b64_tr_b16 v[142:143], v44 offset:35648
    ds_read_b64_tr_b16 v[144:145], v44 offset:34944
    ds_read_b64_tr_b16 v[146:147], v44 offset:35712
    buffer_load_dwordx4 v26, s[4:7], s40 offen lds
    s_add_u32 m0, s57, 89088
    v_mfma_f32_32x32x16_bf16 v[240:255], v[120:123], a[96:99], v[240:255]
    s_waitcnt lgkmcnt(11)
    v_mfma_f32_32x32x16_bf16 v[208:223], v[124:127], a[100:103], v[208:223]
    ds_read_b128 a[108:111], v71 offset:28672
    ds_read_b64_tr_b16 v[112:113], v44 offset:37888
    ds_read_b64_tr_b16 v[114:115], v44 offset:38656
    buffer_load_dwordx4 v27, s[4:7], s40 offen lds
    s_mov_b32 s40, 1572864
    s_add_u32 m0, s58, 102400
    v_mfma_f32_32x32x16_bf16 v[224:239], v[128:131], a[100:103], v[224:239]
    ds_read_b64_tr_b16 v[116:117], v44 offset:37952
    ds_read_b64_tr_b16 v[118:119], v44 offset:38720
    ds_read_b64_tr_b16 v[120:121], v44 offset:38016
    ds_read_b64_tr_b16 v[122:123], v44 offset:38784
    v_mfma_f32_32x32x16_bf16 v[240:255], v[132:135], a[100:103], v[240:255]
    buffer_load_dwordx4 v28, s[12:15], s40 offen lds
    s_add_u32 m0, s58, 103424
    s_waitcnt lgkmcnt(14)
    v_mfma_f32_16x16x32_bf16 v[172:175], v[36:39], v[160:163], v[172:175]
    v_mfma_f32_16x16x32_bf16 v[176:179], v[36:39], v[164:167], v[176:179]
    v_mfma_f32_16x16x32_bf16 v[180:183], v[36:39], v[168:171], v[180:183]
    s_waitcnt lgkmcnt(7)
    v_mfma_f32_32x32x16_bf16 v[208:223], v[136:139], a[104:107], v[208:223]
    buffer_load_dwordx4 v29, s[12:15], s40 offen lds
    s_add_u32 m0, s58, 104448
    s_nop 0
    buffer_load_dwordx4 v30, s[12:15], s40 offen lds
    s_movk_i32 s40, 1152
    s_add_u32 m0, s57, 114688
    s_waitcnt vmcnt(14)
    s_barrier
    ds_read_b128 a[112:115], v72 offset:0
    ds_read_b64_tr_b16 v[124:125], v45 offset:0
    ds_read_b64_tr_b16 v[126:127], v45 offset:768
    v_mfma_f32_32x32x16_bf16 v[224:239], v[140:143], a[104:107], v[224:239]
    ds_read_b64_tr_b16 v[128:129], v45 offset:64
    ds_read_b64_tr_b16 v[130:131], v45 offset:832
    ds_read_b64_tr_b16 v[132:133], v45 offset:128
    ds_read_b64_tr_b16 v[134:135], v45 offset:896
    v_mfma_f32_32x32x16_bf16 v[240:255], v[144:147], a[104:107], v[240:255]
    buffer_load_dwordx4 v24, s[4:7], s40 offen lds
    s_add_u32 m0, s57, 115712
    s_waitcnt lgkmcnt(7)
    v_mfma_f32_32x32x16_bf16 v[208:223], v[112:115], a[108:111], v[208:223]
    ds_read_b128 a[116:119], v73 offset:0
    ds_read_b64_tr_b16 v[136:137], v45 offset:3072
    ds_read_b64_tr_b16 v[138:139], v45 offset:3840
    ds_read_b64_tr_b16 v[160:161], v49 offset:0
    ds_read_b64_tr_b16 v[162:163], v49 offset:768
    v_mfma_f32_32x32x16_bf16 v[224:239], v[116:119], a[108:111], v[224:239]
    ds_read_b64_tr_b16 v[140:141], v45 offset:3136
    ds_read_b64_tr_b16 v[142:143], v45 offset:3904
    ds_read_b64_tr_b16 v[144:145], v45 offset:3200
    ds_read_b64_tr_b16 v[146:147], v45 offset:3968
    ds_read_b64_tr_b16 v[164:165], v49 offset:64
    ds_read_b64_tr_b16 v[166:167], v49 offset:832
    v_mfma_f32_32x32x16_bf16 v[240:255], v[120:123], a[108:111], v[240:255]
    ds_read_b64_tr_b16 v[168:169], v49 offset:128
    ds_read_b64_tr_b16 v[170:171], v49 offset:896
    buffer_load_dwordx4 v25, s[4:7], s40 offen lds
    s_add_u32 m0, s57, 116736
    s_waitcnt lgkmcnt(13)
    v_mfma_f32_32x32x16_bf16 v[208:223], v[124:127], a[112:115], v[208:223]
    ds_read_b128 a[120:123], v74 offset:0
    ds_read_b64_tr_b16 v[112:113], v45 offset:6144
    ds_read_b64_tr_b16 v[114:115], v45 offset:6912
    v_mfma_f32_32x32x16_bf16 v[224:239], v[128:131], a[112:115], v[224:239]
    ds_read_b64_tr_b16 v[116:117], v45 offset:6208
    ds_read_b64_tr_b16 v[118:119], v45 offset:6976
    ds_read_b64_tr_b16 v[120:121], v45 offset:6272
    ds_read_b64_tr_b16 v[122:123], v45 offset:7040
    buffer_load_dwordx4 v26, s[4:7], s40 offen lds
    s_add_u32 m0, s57, 117760
    v_mfma_f32_32x32x16_bf16 v[240:255], v[132:135], a[112:115], v[240:255]
    s_waitcnt lgkmcnt(11)
    v_mfma_f32_32x32x16_bf16 v[208:223], v[136:139], a[116:119], v[208:223]
    ds_read_b128 a[124:127], v75 offset:0
    ds_read_b64_tr_b16 v[124:125], v45 offset:9216
    ds_read_b64_tr_b16 v[126:127], v45 offset:9984
    buffer_load_dwordx4 v27, s[4:7], s40 offen lds
    s_mov_b32 s40, 1769472
    s_add_u32 m0, s58, 131072
    v_mfma_f32_32x32x16_bf16 v[224:239], v[140:143], a[116:119], v[224:239]
    ds_read_b64_tr_b16 v[128:129], v45 offset:9280
    ds_read_b64_tr_b16 v[130:131], v45 offset:10048
    ds_read_b64_tr_b16 v[132:133], v45 offset:9344
    ds_read_b64_tr_b16 v[134:135], v45 offset:10112
    v_mfma_f32_32x32x16_bf16 v[240:255], v[144:147], a[116:119], v[240:255]
    s_waitcnt vmcnt(11)
    v_xor_b32 v16, s47, v16
    buffer_load_dwordx4 v28, s[12:15], s40 offen lds
    s_add_u32 m0, s58, 132096
    v_xor_b32 v17, s47, v17
    v_xor_b32 v18, s47, v18
    s_waitcnt lgkmcnt(14)
    v_mfma_f32_16x16x32_bf16 v[172:175], v[36:39], v[160:163], v[172:175]
    v_xor_b32 v19, s47, v19
    v_or3_b32 v3, v16, v17, v18
    v_mfma_f32_16x16x32_bf16 v[176:179], v[36:39], v[164:167], v[176:179]
    v_or_b32 v3, v3, v19
    v_cmp_ne_u32 vcc, 0, v3
    v_mfma_f32_16x16x32_bf16 v[180:183], v[36:39], v[168:171], v[180:183]
    s_nop 3
    s_cbranch_vccnz Lpoll1
Lpoll1_ret:
    s_waitcnt vmcnt(11)
    v_cmp_ne_u32 vcc, s47, v33
    s_waitcnt lgkmcnt(7)
    v_mfma_f32_32x32x16_bf16 v[208:223], v[112:115], a[120:123], v[208:223]
    s_nop 2
    s_cbranch_vccnz Lpoll2
Lpoll2_ret:
    v_and_b32 v5, 0xffff0000, v32
    v_rcp_f32 v4, v5
    v_lshlrev_b32 v8, 16, v32
    v_cvt_pk_bf16_f32 v40, v8, v8
    buffer_load_dwordx4 v29, s[12:15], s40 offen lds
    s_add_u32 m0, s58, 133120
    v_mul_f32 v8, 0.5, v8
    v_cvt_pk_bf16_f32 v56, v8, v8
    v_mul_f32 v6, 0xbfb8aa3b, v4
    v_mov_b32 v41, v40
    v_mov_b32 v57, v56
    v_mov_b32 v42, v40
    v_mov_b32 v58, v56
    v_mov_b32 v43, v40
    v_mov_b32 v59, v56
    buffer_load_dwordx4 v30, s[12:15], s40 offen lds
    s_waitcnt vmcnt(7)
    s_barrier
    ds_read_b128 a[128:131], v72 offset:28672
    ds_read_b64_tr_b16 v[136:137], v45 offset:28672
    ds_read_b64_tr_b16 v[138:139], v45 offset:29440
    v_mfma_f32_32x32x16_bf16 v[224:239], v[116:119], a[120:123], v[224:239]
    ds_read_b64_tr_b16 v[140:141], v45 offset:28736
    ds_read_b64_tr_b16 v[142:143], v45 offset:29504
    ds_read_b64_tr_b16 v[144:145], v45 offset:28800
    ds_read_b64_tr_b16 v[146:147], v45 offset:29568
    s_add_u32 s40, s8, 0
    s_add_u32 m0, s10, 0
    v_mfma_f32_32x32x16_bf16 v[240:255], v[120:123], a[120:123], v[240:255]
    buffer_load_dwordx4 v2, s[20:23], s40 offen offset:0 sc1 lds
    buffer_load_dwordx4 v2, s[20:23], s40 offen offset:1024 sc1 lds
    ds_read_b64_tr_b16 v[184:185], v106 offset:0
    ds_read_b64_tr_b16 v[186:187], v106 offset:640
    ds_read_b64_tr_b16 v[188:189], v106 offset:8
    s_waitcnt lgkmcnt(10)
    v_mfma_f32_32x32x16_bf16 v[208:223], v[124:127], a[124:127], v[208:223]
    ds_read_b128 a[132:135], v73 offset:28672
    ds_read_b64_tr_b16 v[112:113], v45 offset:31744
    ds_read_b64_tr_b16 v[114:115], v45 offset:32512
    ds_read_b64_tr_b16 v[160:161], v49 offset:28672
    ds_read_b64_tr_b16 v[162:163], v49 offset:29440
    ds_read_b64_tr_b16 v[190:191], v106 offset:648
    v_mfma_f32_32x32x16_bf16 v[224:239], v[128:131], a[124:127], v[224:239]
    ds_read_b64_tr_b16 v[116:117], v45 offset:31808
    ds_read_b64_tr_b16 v[118:119], v45 offset:32576
    ds_read_b64_tr_b16 v[120:121], v45 offset:31872
    ds_read_b64_tr_b16 v[122:123], v45 offset:32640
    ds_read_b64_tr_b16 v[164:165], v49 offset:28736
    ds_read_b64_tr_b16 v[166:167], v49 offset:29504
    v_mfma_f32_32x32x16_bf16 v[240:255], v[132:135], a[124:127], v[240:255]
    ds_read_b64_tr_b16 v[168:169], v49 offset:28800
    ds_read_b64_tr_b16 v[170:171], v49 offset:29568
    buffer_load_dwordx4 v2, s[20:23], s40 offen offset:2048 sc1 lds
    ds_read_b64_tr_b16 v[192:193], v106 offset:16
    ds_read_b64_tr_b16 v[194:195], v106 offset:656
    s_waitcnt lgkmcnt(15)
    v_mfma_f32_32x32x16_bf16 v[208:223], v[136:139], a[128:131], v[208:223]
    ds_read_b128 a[136:139], v74 offset:28672
    ds_read_b64_tr_b16 v[124:125], v45 offset:34816
    ds_read_b64_tr_b16 v[126:127], v45 offset:35584
    ds_read_b64_tr_b16 v[196:197], v106 offset:24
    buffer_load_dwordx4 v2, s[20:23], s40 offen offset:3072 sc1 lds
    s_add_u32 s40, s8, 4096
    v_mfma_f32_32x32x16_bf16 v[224:239], v[140:143], a[128:131], v[224:239]
    ds_read_b64_tr_b16 v[128:129], v45 offset:34880
    ds_read_b64_tr_b16 v[130:131], v45 offset:35648
    ds_read_b64_tr_b16 v[132:133], v45 offset:34944
    ds_read_b64_tr_b16 v[134:135], v45 offset:35712
    s_add_u32 m0, s10, 4096
    ds_read_b64_tr_b16 v[198:199], v106 offset:664
    v_mfma_f32_32x32x16_bf16 v[240:255], v[144:147], a[128:131], v[240:255]
    ds_read_b64_tr_b16 v[200:201], v106 offset:32
    ds_read_b64_tr_b16 v[202:203], v106 offset:672
    buffer_store_dwordx4 v[184:187], v2, s[20:23], s55 offen offset:0 sc1
    s_waitcnt lgkmcnt(15)
    buffer_store_dwordx4 v[188:191], v2, s[20:23], s55 offen offset:1024 sc1
    v_mfma_f32_32x32x16_bf16 v[208:223], v[112:115], a[132:135], v[208:223]
    ds_read_b128 a[140:143], v75 offset:28672
    ds_read_b64_tr_b16 v[136:137], v45 offset:37888
    ds_read_b64_tr_b16 v[138:139], v45 offset:38656
    s_waitcnt lgkmcnt(14)
    buffer_store_dwordx4 v[192:195], v2, s[20:23], s55 offen offset:2048 sc1
    v_mfma_f32_32x32x16_bf16 v[224:239], v[116:119], a[132:135], v[224:239]
    ds_read_b64_tr_b16 v[140:141], v45 offset:37952
    ds_read_b64_tr_b16 v[142:143], v45 offset:38720
    ds_read_b64_tr_b16 v[144:145], v45 offset:38016
    ds_read_b64_tr_b16 v[146:147], v45 offset:38784
    v_mfma_f32_32x32x16_bf16 v[240:255], v[120:123], a[132:135], v[240:255]
    s_waitcnt lgkmcnt(9)
    buffer_store_dwordx4 v[196:199], v2, s[20:23], s55 offen offset:3072 sc1
    v_mfma_f32_16x16x32_bf16 v[172:175], v[36:39], v[160:163], v[172:175]
    s_waitcnt lgkmcnt(7)
    buffer_store_dwordx4 v[200:203], v107, s[20:23], s55 offen offset:0 sc1
    s_lshr_b32 s45, s44, 1
    v_mfma_f32_16x16x32_bf16 v[176:179], v[36:39], v[164:167], v[176:179]
    s_lshl1_add_u32 s11, s49, s45
    s_lshl4_add_u32 s12, s11, s50
    v_mfma_f32_16x16x32_bf16 v[180:183], v[36:39], v[168:171], v[180:183]
    s_mul_i32 s11, s11, 278528
    s_and_b32 s45, s44, 1
    v_mfma_f32_32x32x16_bf16 v[208:223], v[124:127], a[136:139], v[208:223]
    s_lshl1_add_u32 s12, s12, s45
    s_lshl_b32 s12, s12, 7
    s_lshl_b32 s45, s45, 11
    s_add_u32 s11, s11, s45
    s_add_u32 s11, s11, 5472256
    v_and_b32 v9, 15, v1
    v_lshlrev_b32 v9, 4, v9
    v_bfe_u32 v10, v1, 4, 1
    v_lshl_add_u32 v24, v10, 10, v9
    v_lshl_add_u32 v25, v21, 8, v24
    s_mul_i32 s45, s50, 12288
    s_add_u32 s56, s11, s45
    s_mul_i32 s45, s52, 348160
    s_mul_i32 s46, s44, 61440
    s_add_u32 s14, s45, s46
    s_mul_i32 s46, s44, 25600
    s_add_u32 s15, s45, s46
    s_mul_i32 s45, s51, 278528
    s_mul_i32 s46, s44, 49152
    s_add_u32 s16, s45, s46
    s_mul_i32 s46, s44, 20480
    s_add_u32 s17, s45, s46
    v_add_u32 v26, 4096, v2
    s_add_u32 s45, s44, 1
    buffer_load_dwordx4 v2, s[20:23], s40 offen offset:0 sc1 lds
    s_and_b32 s45, s45, 3
    s_lshl_b32 s45, s45, 10
    v_add_u32 v32, s45, v2
    s_add_u32 s45, s44, 2
    s_and_b32 s45, s45, 3
    s_lshl_b32 s45, s45, 10
    v_add_u32 v33, s45, v2
    s_add_u32 s45, s44, 3
    s_and_b32 s45, s45, 3
    s_lshl_b32 s45, s45, 10
    s_waitcnt vmcnt(10)
    s_barrier
    ds_read_b128 a[144:147], v76 offset:0
    ds_read_b64_tr_b16 v[112:113], v46 offset:0
    ds_read_b64_tr_b16 v[114:115], v46 offset:768
    v_mfma_f32_32x32x16_bf16 v[224:239], v[128:131], a[136:139], v[224:239]
    ds_read_b64_tr_b16 v[116:117], v46 offset:64
    ds_read_b64_tr_b16 v[118:119], v46 offset:832
    ds_read_b64_tr_b16 v[120:121], v46 offset:128
    ds_read_b64_tr_b16 v[122:123], v46 offset:896
    buffer_load_dwordx4 v2, s[20:23], s40 offen offset:1024 sc1 lds
    v_add_u32 v34, s45, v2
    v_mfma_f32_32x32x16_bf16 v[240:255], v[132:135], a[136:139], v[240:255]
    s_add_u32 s45, s44, 4
    s_and_b32 s45, s45, 3
    s_lshl_b32 s45, s45, 10
    v_add_u32 v35, s45, v2
    s_mul_i32 s46, s44, 12
    s_waitcnt lgkmcnt(7)
    v_mfma_f32_32x32x16_bf16 v[208:223], v[136:139], a[140:143], v[208:223]
    ds_read_b128 a[148:151], v77 offset:0
    ds_read_b64_tr_b16 v[124:125], v46 offset:3072
    ds_read_b64_tr_b16 v[126:127], v46 offset:3840
    ds_read_b64_tr_b16 v[160:161], v50 offset:0
    ds_read_b64_tr_b16 v[162:163], v50 offset:768
    buffer_load_dwordx4 v2, s[20:23], s40 offen offset:2048 sc1 lds
    v_mfma_f32_32x32x16_bf16 v[224:239], v[140:143], a[140:143], v[224:239]
    ds_read_b64_tr_b16 v[128:129], v46 offset:3136
    ds_read_b64_tr_b16 v[130:131], v46 offset:3904
    ds_read_b64_tr_b16 v[132:133], v46 offset:3200
    ds_read_b64_tr_b16 v[134:135], v46 offset:3968
    ds_read_b64_tr_b16 v[164:165], v50 offset:64
    ds_read_b64_tr_b16 v[166:167], v50 offset:832
    v_mfma_f32_32x32x16_bf16 v[240:255], v[144:147], a[140:143], v[240:255]
    ds_read_b64_tr_b16 v[168:169], v50 offset:128
    ds_read_b64_tr_b16 v[170:171], v50 offset:896
    s_lshl_b32 s55, s52, 7
    buffer_load_dwordx4 v2, s[20:23], s40 offen offset:3072 sc1 lds
    s_add_u32 s40, s8, 8192
    s_waitcnt lgkmcnt(13)
    v_mfma_f32_32x32x16_bf16 v[208:223], v[112:115], a[144:147], v[208:223]
    ds_read_b128 a[152:155], v78 offset:0
    ds_read_b64_tr_b16 v[136:137], v46 offset:6144
    ds_read_b64_tr_b16 v[138:139], v46 offset:6912
    s_add_u32 m0, s10, 8192
    s_add_u32 s46, s46, s55
    v_min_u32 v8, 16, v1
    v_mfma_f32_32x32x16_bf16 v[224:239], v[116:119], a[144:147], v[224:239]
    ds_read_b64_tr_b16 v[140:141], v46 offset:6208
    ds_read_b64_tr_b16 v[142:143], v46 offset:6976
    ds_read_b64_tr_b16 v[144:145], v46 offset:6272
    ds_read_b64_tr_b16 v[146:147], v46 offset:7040
    v_add_u32 v9, s46, v8
    buffer_load_dwordx4 v2, s[20:23], s40 offen offset:0 sc1 lds
    v_mfma_f32_32x32x16_bf16 v[240:255], v[120:123], a[144:147], v[240:255]
    s_mul_i32 s46, s44, 5
    s_add_u32 s46, s46, s55
    s_add_u32 s46, s46, 36
    v_add_u32 v10, s46, v8
    v_cmp_gt_u32 vcc, 12, v8
    s_waitcnt lgkmcnt(11)
    v_mfma_f32_32x32x16_bf16 v[208:223], v[124:127], a[148:151], v[208:223]
    ds_read_b128 a[156:159], v79 offset:0
    ds_read_b64_tr_b16 v[112:113], v46 offset:9216
    ds_read_b64_tr_b16 v[114:115], v46 offset:9984
    v_cndmask_b32 v9, v10, v9, vcc
    v_lshlrev_b32 v9, 2, v9
    v_add_u32 v13, 15303680, v9
    v_mfma_f32_32x32x16_bf16 v[224:239], v[128:131], a[148:151], v[224:239]
    ds_read_b64_tr_b16 v[116:117], v46 offset:9280
    ds_read_b64_tr_b16 v[118:119], v46 offset:10048
    ds_read_b64_tr_b16 v[120:121], v46 offset:9344
    ds_read_b64_tr_b16 v[122:123], v46 offset:10112
    buffer_load_dwordx4 v2, s[20:23], s40 offen offset:1024 sc1 lds
    s_add_u32 s40, s9, 40960
    v_mfma_f32_32x32x16_bf16 v[240:255], v[132:135], a[148:151], v[240:255]
    s_cmp_eq_u32 s44, 0
    s_cselect_b32 s40, s40, 0x40000000
    s_cselect_b32 m0, 40960, s3
    s_lshl_b32 s13, s51, 5
    s_lshl3_add_u32 s13, s44, s13
    s_waitcnt lgkmcnt(14)
    v_mfma_f32_16x16x32_bf16 v[172:175], v[36:39], v[160:163], v[172:175]
    buffer_load_dwordx4 v2, s[20:23], s40 offen sc1 lds
    s_add_u32 s40, s8, 41984
    v_mfma_f32_16x16x32_bf16 v[176:179], v[36:39], v[164:167], v[176:179]
    s_add_u32 m0, s10, 41984
    s_nop 0
    buffer_load_dwordx4 v2, s[20:23], s40 offen offset:0 sc1 lds
    v_mfma_f32_16x16x32_bf16 v[180:183], v[36:39], v[168:171], v[180:183]
    v_lshlrev_b32 v8, 4, v22
    v_add_u32 v8, 159744, v8
    s_waitcnt lgkmcnt(7)
    v_mfma_f32_32x32x16_bf16 v[208:223], v[136:139], a[152:155], v[208:223]
    s_lshl_b32 s45, s44, 2
    v_add_u32 v9, s45, v8
    v_cvt_pk_bf16_f32 v10, v172, v172
    v_lshlrev_b32 v10, 16, v10
    v_sub_f32 v10, v172, v10
    v_cvt_pk_bf16_f32 v173, v172, v10
    v_mfma_f32_32x32x16_bf16 v[224:239], v[140:143], a[152:155], v[224:239]
    ds_write_b32 v9, v173 offset:0
    v_cvt_pk_bf16_f32 v10, v176, v176
    v_lshlrev_b32 v10, 16, v10
    buffer_load_dwordx4 v2, s[20:23], s40 offen offset:1024 sc1 lds
    v_sub_f32 v10, v176, v10
    v_cvt_pk_bf16_f32 v177, v176, v10
    v_mfma_f32_32x32x16_bf16 v[240:255], v[144:147], a[152:155], v[240:255]
    ds_write_b32 v9, v177 offset:512
    v_cvt_pk_bf16_f32 v10, v180, v180
    v_lshlrev_b32 v10, 16, v10
    v_sub_f32 v10, v180, v10
    v_cvt_pk_bf16_f32 v181, v180, v10
    s_waitcnt lgkmcnt(2)
    v_mfma_f32_32x32x16_bf16 v[208:223], v[112:115], a[156:159], v[208:223]
    ds_write_b32 v9, v181 offset:1024
    v_mov_b32 v174, v8
    buffer_load_dwordx4 v2, s[20:23], s40 offen offset:2048 sc1 lds
    buffer_load_dwordx4 v2, s[20:23], s40 offen offset:3072 sc1 lds
    s_add_u32 s40, s8, 46080
    s_add_u32 m0, s10, 46080
    s_nop 0
    buffer_load_dwordx4 v2, s[20:23], s40 offen offset:0 sc1 lds
    buffer_load_dwordx4 v2, s[20:23], s40 offen offset:1024 sc1 lds
    buffer_load_dwordx4 v2, s[20:23], s40 offen offset:2048 sc1 lds
    buffer_load_dwordx4 v2, s[20:23], s40 offen offset:3072 sc1 lds
    s_add_u32 s40, s8, 50176
    s_add_u32 m0, s10, 50176
    s_nop 0
    buffer_load_dwordx4 v2, s[20:23], s40 offen offset:0 sc1 lds
    buffer_load_dwordx4 v2, s[20:23], s40 offen offset:1024 sc1 lds
    s_add_u32 s40, s9, 82944
    s_cmp_eq_u32 s44, 1
    s_cselect_b32 s40, s40, 0x40000000
    s_cselect_b32 m0, 82944, s3
    s_nop 0
    buffer_load_dwordx4 v2, s[20:23], s40 offen sc1 lds
    s_waitcnt vmcnt(11)
    s_waitcnt lgkmcnt(0)
    s_barrier
    ds_read_b128 v[184:187], v2 offset:0
    ds_read_b128 v[188:191], v2 offset:1024
    ds_read_b128 v[192:195], v2 offset:2048
    ds_read_b128 v[196:199], v2 offset:3072
    ds_read_b128 v[200:203], v2 offset:4096
    ds_read_b128 v[160:163], v174 offset:0
    ds_read_b128 v[164:167], v174 offset:512
    ds_read_b128 v[168:171], v174 offset:1024
    v_mfma_f32_32x32x16_bf16 v[224:239], v[116:119], a[156:159], v[224:239]
    s_add_u32 s40, s8, 83968
    s_add_u32 m0, s10, 83968
    s_nop 0
    buffer_load_dwordx4 v2, s[20:23], s40 offen offset:0 sc1 lds
    buffer_load_dwordx4 v2, s[20:23], s40 offen offset:1024 sc1 lds
    buffer_store_dword v11, v12, s[20:23], 0 offen sc1
    v_mfma_f32_32x32x16_bf16 v[240:255], v[120:123], a[156:159], v[240:255]
    s_waitcnt lgkmcnt(6)
    v_mfma_f32_32x32x16_bf16 v[96:111], v[184:187], a[0:3], 0
    ds_read_b128 v[204:207], v2 offset:5120
    buffer_load_dwordx4 v2, s[20:23], s40 offen offset:2048 sc1 lds
    v_mfma_f32_32x32x16_bf16 v[96:111], v[188:191], a[4:7], v[96:111]
    ds_read_b128 v[184:187], v2 offset:6144
    s_waitcnt lgkmcnt(4)
    v_mfma_f32_32x32x16_bf16 v[208:223], v[160:163], v[56:59], v[208:223]
    buffer_load_dwordx4 v2, s[20:23], s40 offen offset:3072 sc1 lds
    s_add_u32 s40, s8, 88064
    s_add_u32 m0, s10, 88064
    s_waitcnt lgkmcnt(3)
    v_mfma_f32_32x32x16_bf16 v[224:239], v[164:167], v[56:59], v[224:239]
    s_waitcnt lgkmcnt(2)
    v_mfma_f32_32x32x16_bf16 v[240:255], v[168:171], v[56:59], v[240:255]
    s_nop 4
    v_mul_f32 v68, v6, v208
    v_mul_f32 v69, v6, v209
    v_mul_f32 v70, v6, v210
    v_mul_f32 v71, v6, v211
    v_mul_f32 v72, v6, v212
    buffer_load_dwordx4 v2, s[20:23], s40 offen offset:0 sc1 lds
    v_mfma_f32_32x32x16_bf16 v[96:111], v[192:195], a[8:11], v[96:111]
    ds_read_b128 v[188:191], v2 offset:7168
    v_mul_f32 v73, v6, v213
    v_mul_f32 v74, v6, v214
    v_mul_f32 v75, v6, v215
    v_exp_f32 v68, v68
    v_mfma_f32_32x32x16_bf16 v[96:111], v[196:199], a[12:15], v[96:111]
    ds_read_b128 v[192:195], v2 offset:8192
    v_exp_f32 v69, v69
    v_exp_f32 v70, v70
    s_waitcnt lgkmcnt(3)
    v_mfma_f32_32x32x16_bf16 v[96:111], v[200:203], a[16:19], v[96:111]
    ds_read_b128 v[196:199], v2 offset:9216
    buffer_load_dwordx4 v2, s[20:23], s40 offen offset:1024 sc1 lds
    v_exp_f32 v71, v71
    v_exp_f32 v72, v72
    v_mfma_f32_32x32x16_bf16 v[96:111], v[204:207], a[20:23], v[96:111]
    ds_read_b128 v[200:203], v2 offset:10240
    v_exp_f32 v73, v73
    v_exp_f32 v74, v74
    s_waitcnt lgkmcnt(3)
    v_mfma_f32_32x32x16_bf16 v[96:111], v[184:187], a[24:27], v[96:111]
    ds_read_b128 v[204:207], v2 offset:11264
    buffer_load_dwordx4 v2, s[20:23], s40 offen offset:2048 sc1 lds
    v_exp_f32 v75, v75
    v_fma_f32 v68, v68, v5, v5
    v_fma_f32 v69, v69, v5, v5
    v_mfma_f32_32x32x16_bf16 v[96:111], v[188:191], a[28:31], v[96:111]
    ds_read_b128 v[184:187], v2 offset:12288
    v_fma_f32 v70, v70, v5, v5
    v_fma_f32 v71, v71, v5, v5
    v_fma_f32 v72, v72, v5, v5
    v_fma_f32 v73, v73, v5, v5
    s_waitcnt lgkmcnt(3)
    v_mfma_f32_32x32x16_bf16 v[96:111], v[192:195], a[32:35], v[96:111]
    ds_read_b128 v[188:191], v2 offset:13312
    buffer_load_dwordx4 v2, s[20:23], s40 offen offset:3072 sc1 lds
    s_add_u32 s40, s8, 92160
    s_add_u32 m0, s10, 92160
    v_fma_f32 v74, v74, v5, v5
    v_fma_f32 v75, v75, v5, v5
    v_mfma_f32_32x32x16_bf16 v[96:111], v[196:199], a[36:39], v[96:111]
    ds_read_b128 v[192:195], v2 offset:14336
    v_rcp_f32 v68, v68
    v_rcp_f32 v69, v69
    s_waitcnt lgkmcnt(3)
    v_mfma_f32_32x32x16_bf16 v[96:111], v[200:203], a[40:43], v[96:111]
    ds_read_b128 v[196:199], v2 offset:15360
    v_rcp_f32 v70, v70
    buffer_load_dwordx4 v2, s[20:23], s40 offen offset:0 sc1 lds
    v_rcp_f32 v71, v71
    v_mfma_f32_32x32x16_bf16 v[96:111], v[204:207], a[44:47], v[96:111]
    ds_read_b128 v[200:203], v2 offset:16384
    v_rcp_f32 v72, v72
    v_rcp_f32 v73, v73
    s_waitcnt lgkmcnt(3)
    v_mfma_f32_32x32x16_bf16 v[96:111], v[184:187], a[48:51], v[96:111]
    ds_read_b128 v[204:207], v2 offset:17408
    v_rcp_f32 v74, v74
    v_rcp_f32 v75, v75
    buffer_load_dwordx4 v2, s[20:23], s40 offen offset:1024 sc1 lds
    v_mfma_f32_32x32x16_bf16 v[96:111], v[188:191], a[52:55], v[96:111]
    ds_read_b128 v[184:187], v2 offset:18432
    s_add_u32 s40, s9, 124928
    s_cmp_eq_u32 s44, 2
    s_cselect_b32 s40, s40, 0x40000000
    s_cselect_b32 m0, 124928, s3
    s_waitcnt lgkmcnt(3)
    v_mfma_f32_32x32x16_bf16 v[96:111], v[192:195], a[56:59], v[96:111]
    ds_read_b128 v[188:191], v2 offset:19456
    v_mul_f32 v208, v208, v68
    v_mul_f32 v209, v209, v69
    v_mul_f32 v210, v210, v70
    v_mul_f32 v211, v211, v71
    v_mul_f32 v212, v212, v72
    v_mfma_f32_32x32x16_bf16 v[96:111], v[196:199], a[60:63], v[96:111]
    ds_read_b128 v[192:195], v2 offset:20480
    buffer_load_dwordx4 v2, s[20:23], s40 offen sc1 lds
    v_mul_f32 v213, v213, v73
    v_mul_f32 v214, v214, v74
    v_mul_f32 v215, v215, v75
    s_waitcnt lgkmcnt(3)
    v_mfma_f32_32x32x16_bf16 v[96:111], v[200:203], a[64:67], v[96:111]
    ds_read_b128 v[196:199], v2 offset:21504
    v_cvt_pk_bf16_f32 v152, v208, v209
    v_cvt_pk_bf16_f32 v153, v210, v211
    v_cvt_pk_bf16_f32 v154, v212, v213
    v_cvt_pk_bf16_f32 v155, v214, v215
    buffer_store_dwordx4 v[152:155], v25, s[20:23], s56 offen offset:0 sc1
    v_mfma_f32_32x32x16_bf16 v[96:111], v[204:207], a[68:71], v[96:111]
    ds_read_b128 v[200:203], v2 offset:22528
    v_mul_f32 v68, v6, v216
    v_mul_f32 v69, v6, v217
    v_mul_f32 v70, v6, v218
    v_mul_f32 v71, v6, v219
    s_waitcnt lgkmcnt(3)
    v_mfma_f32_32x32x16_bf16 v[96:111], v[184:187], a[72:75], v[96:111]
    ds_read_b128 v[204:207], v2 offset:23552
    v_mul_f32 v72, v6, v220
    v_mul_f32 v73, v6, v221
    v_mul_f32 v74, v6, v222
    v_mul_f32 v75, v6, v223
    v_exp_f32 v68, v68
    v_mfma_f32_32x32x16_bf16 v[96:111], v[188:191], a[76:79], v[96:111]
    ds_read_b128 v[184:187], v2 offset:24576
    v_exp_f32 v69, v69
    v_exp_f32 v70, v70
    s_waitcnt lgkmcnt(3)
    v_mfma_f32_32x32x16_bf16 v[96:111], v[192:195], a[80:83], v[96:111]
    ds_read_b128 v[188:191], v2 offset:25600
    v_exp_f32 v71, v71
    v_exp_f32 v72, v72
    v_exp_f32 v73, v73
    v_mfma_f32_32x32x16_bf16 v[96:111], v[196:199], a[84:87], v[96:111]
    ds_read_b128 v[192:195], v2 offset:26624
    v_exp_f32 v74, v74
    v_exp_f32 v75, v75
    s_waitcnt lgkmcnt(3)
    v_mfma_f32_32x32x16_bf16 v[96:111], v[200:203], a[88:91], v[96:111]
    ds_read_b128 v[196:199], v2 offset:27648
    v_fma_f32 v68, v68, v5, v5
    v_fma_f32 v69, v69, v5, v5
    v_fma_f32 v70, v70, v5, v5
    v_fma_f32 v71, v71, v5, v5
    v_fma_f32 v72, v72, v5, v5
    v_mfma_f32_32x32x16_bf16 v[96:111], v[204:207], a[92:95], v[96:111]
    ds_read_b128 v[200:203], v2 offset:28672
    v_fma_f32 v73, v73, v5, v5
    v_fma_f32 v74, v74, v5, v5
    v_fma_f32 v75, v75, v5, v5
    v_rcp_f32 v68, v68
    s_waitcnt lgkmcnt(3)
    v_mfma_f32_32x32x16_bf16 v[96:111], v[184:187], a[96:99], v[96:111]
    ds_read_b128 v[204:207], v2 offset:29696
    v_rcp_f32 v69, v69
    v_rcp_f32 v70, v70
    v_rcp_f32 v71, v71
    v_mfma_f32_32x32x16_bf16 v[96:111], v[188:191], a[100:103], v[96:111]
    ds_read_b128 v[184:187], v2 offset:30720
    v_rcp_f32 v72, v72
    v_rcp_f32 v73, v73
    s_waitcnt lgkmcnt(3)
    v_mfma_f32_32x32x16_bf16 v[96:111], v[192:195], a[104:107], v[96:111]
    ds_read_b128 v[188:191], v2 offset:31744
    v_rcp_f32 v74, v74
    v_rcp_f32 v75, v75
    v_mul_f32 v216, v216, v68
    v_mfma_f32_32x32x16_bf16 v[96:111], v[196:199], a[108:111], v[96:111]
    ds_read_b128 v[192:195], v2 offset:32768
    v_mul_f32 v217, v217, v69
    v_mul_f32 v218, v218, v70
    v_mul_f32 v219, v219, v71
    v_mul_f32 v220, v220, v72
    s_waitcnt lgkmcnt(3)
    v_mfma_f32_32x32x16_bf16 v[96:111], v[200:203], a[112:115], v[96:111]
    ds_read_b128 v[196:199], v2 offset:33792
    v_mul_f32 v221, v221, v73
    v_mul_f32 v222, v222, v74
    v_mul_f32 v223, v223, v75
    v_cvt_pk_bf16_f32 v156, v216, v217
    v_cvt_pk_bf16_f32 v157, v218, v219
    v_mfma_f32_32x32x16_bf16 v[96:111], v[204:207], a[116:119], v[96:111]
    ds_read_b128 v[200:203], v2 offset:34816
    v_cvt_pk_bf16_f32 v158, v220, v221
    v_cvt_pk_bf16_f32 v159, v222, v223
    buffer_store_dwordx4 v[156:159], v25, s[20:23], s56 offen offset:512 sc1
    s_add_u32 s56, s56, 4096
    s_waitcnt lgkmcnt(3)
    v_mfma_f32_32x32x16_bf16 v[96:111], v[184:187], a[120:123], v[96:111]
    ds_read_b128 v[204:207], v2 offset:35840
    v_mul_f32 v68, v6, v224
    v_mul_f32 v69, v6, v225
    v_mul_f32 v70, v6, v226
    v_mul_f32 v71, v6, v227
    v_mul_f32 v72, v6, v228
    v_mfma_f32_32x32x16_bf16 v[96:111], v[188:191], a[124:127], v[96:111]
    ds_read_b128 v[184:187], v2 offset:36864
    v_mul_f32 v73, v6, v229
    v_mul_f32 v74, v6, v230
    v_mul_f32 v75, v6, v231
    v_exp_f32 v68, v68
    s_waitcnt lgkmcnt(3)
    v_mfma_f32_32x32x16_bf16 v[96:111], v[192:195], a[128:131], v[96:111]
    ds_read_b128 v[188:191], v2 offset:37888
    v_exp_f32 v69, v69
    v_exp_f32 v70, v70
    v_exp_f32 v71, v71
    v_mfma_f32_32x32x16_bf16 v[96:111], v[196:199], a[132:135], v[96:111]
    ds_read_b128 v[192:195], v2 offset:38912
    v_exp_f32 v72, v72
    v_exp_f32 v73, v73
    s_waitcnt lgkmcnt(3)
    v_mfma_f32_32x32x16_bf16 v[96:111], v[200:203], a[136:139], v[96:111]
    ds_read_b128 v[196:199], v2 offset:39936
    v_exp_f32 v74, v74
    v_exp_f32 v75, v75
    v_fma_f32 v68, v68, v5, v5
    v_mfma_f32_32x32x16_bf16 v[96:111], v[204:207], a[140:143], v[96:111]
    ds_read_b128 v[200:203], v2 offset:40960
    v_fma_f32 v69, v69, v5, v5
    v_fma_f32 v70, v70, v5, v5
    v_fma_f32 v71, v71, v5, v5
    v_fma_f32 v72, v72, v5, v5
    s_waitcnt lgkmcnt(3)
    v_mfma_f32_32x32x16_bf16 v[96:111], v[184:187], a[144:147], v[96:111]
    s_waitcnt vmcnt(14)
    s_barrier
    ds_read_b128 v[204:207], v7 offset:0
    v_fma_f32 v73, v73, v5, v5
    v_fma_f32 v74, v74, v5, v5
    v_fma_f32 v75, v75, v5, v5
    v_rcp_f32 v68, v68
    v_mfma_f32_32x32x16_bf16 v[96:111], v[188:191], a[148:151], v[96:111]
    ds_read_b128 v[184:187], v7 offset:1024
    v_rcp_f32 v69, v69
    v_rcp_f32 v70, v70
    s_waitcnt lgkmcnt(3)
    v_mfma_f32_32x32x16_bf16 v[96:111], v[192:195], a[152:155], v[96:111]
    ds_read_b128 v[188:191], v7 offset:2048
    v_rcp_f32 v71, v71
    v_rcp_f32 v72, v72
    v_rcp_f32 v73, v73
    v_mfma_f32_32x32x16_bf16 v[96:111], v[196:199], a[156:159], v[96:111]
    ds_read_b128 v[192:195], v7 offset:3072
    v_rcp_f32 v74, v74
    v_rcp_f32 v75, v75
    s_waitcnt lgkmcnt(3)
    v_mfma_f32_32x32x16_bf16 v[96:111], v[200:203], v[40:43], v[96:111]
    ds_read_b128 v[196:199], v7 offset:4096
    v_mul_f32 v224, v224, v68
    v_mul_f32 v225, v225, v69
    v_mul_f32 v226, v226, v70
    v_mul_f32 v227, v227, v71
    v_mul_f32 v228, v228, v72
    v_mfma_f32_32x32x16_bf16 v[112:127], v[204:207], a[0:3], 0
    ds_read_b128 v[200:203], v7 offset:5120
    v_mul_f32 v229, v229, v73
    v_mul_f32 v230, v230, v74
    v_mul_f32 v231, v231, v75
    v_cvt_pk_bf16_f32 v152, v224, v225
    s_waitcnt lgkmcnt(3)
    v_mfma_f32_32x32x16_bf16 v[112:127], v[184:187], a[4:7], v[112:127]
    ds_read_b128 v[204:207], v7 offset:6144
    v_cvt_pk_bf16_f32 v153, v226, v227
    v_cvt_pk_bf16_f32 v154, v228, v229
    v_cvt_pk_bf16_f32 v155, v230, v231
    buffer_store_dwordx4 v[152:155], v25, s[20:23], s56 offen offset:0 sc1
    v_mul_f32 v68, v6, v232
    v_mfma_f32_32x32x16_bf16 v[112:127], v[188:191], a[8:11], v[112:127]
    ds_read_b128 v[184:187], v7 offset:7168
    v_mul_f32 v69, v6, v233
    v_mul_f32 v70, v6, v234
    v_mul_f32 v71, v6, v235
    v_mul_f32 v72, v6, v236
    s_waitcnt lgkmcnt(3)
    v_mfma_f32_32x32x16_bf16 v[112:127], v[192:195], a[12:15], v[112:127]
    s_barrier
    ds_read_b128 v[188:191], v7 offset:8192
    s_add_u32 s40, s8, 125952
    s_add_u32 m0, s10, 0
    s_nop 0
    buffer_load_dwordx4 v31, s[20:23], s40 offen offset:0 sc1 lds
    v_mul_f32 v73, v6, v237
    v_mfma_f32_32x32x16_bf16 v[112:127], v[196:199], a[16:19], v[112:127]
    ds_read_b128 v[192:195], v7 offset:9216
    buffer_load_dwordx4 v31, s[20:23], s40 offen offset:1024 sc1 lds
    v_mul_f32 v74, v6, v238
    v_mul_f32 v75, v6, v239
    v_exp_f32 v68, v68
    s_waitcnt lgkmcnt(3)
    v_mfma_f32_32x32x16_bf16 v[112:127], v[200:203], a[20:23], v[112:127]
    ds_read_b128 v[196:199], v7 offset:10240
    v_exp_f32 v69, v69
    v_exp_f32 v70, v70
    v_exp_f32 v71, v71
    v_mfma_f32_32x32x16_bf16 v[112:127], v[204:207], a[24:27], v[112:127]
    ds_read_b128 v[200:203], v7 offset:11264
    buffer_load_dwordx4 v31, s[20:23], s40 offen offset:2048 sc1 lds
    v_exp_f32 v72, v72
    v_exp_f32 v73, v73
    s_waitcnt lgkmcnt(3)
    v_mfma_f32_32x32x16_bf16 v[112:127], v[184:187], a[28:31], v[112:127]
    ds_read_b128 v[204:207], v7 offset:12288
    v_exp_f32 v74, v74
    v_exp_f32 v75, v75
    v_fma_f32 v68, v68, v5, v5
    v_mfma_f32_32x32x16_bf16 v[112:127], v[188:191], a[32:35], v[112:127]
    ds_read_b128 v[184:187], v7 offset:13312
    buffer_load_dwordx4 v31, s[20:23], s40 offen offset:3072 sc1 lds
    s_add_u32 s40, s8, 130048
    s_add_u32 m0, s10, 4096
    v_fma_f32 v69, v69, v5, v5
    s_waitcnt lgkmcnt(3)
    v_mfma_f32_32x32x16_bf16 v[112:127], v[192:195], a[36:39], v[112:127]
    ds_read_b128 v[188:191], v7 offset:14336
    v_fma_f32 v70, v70, v5, v5
    v_fma_f32 v71, v71, v5, v5
    v_fma_f32 v72, v72, v5, v5
    v_fma_f32 v73, v73, v5, v5
    v_fma_f32 v74, v74, v5, v5
    v_mfma_f32_32x32x16_bf16 v[112:127], v[196:199], a[40:43], v[112:127]
    ds_read_b128 v[192:195], v7 offset:15360
    buffer_load_dwordx4 v31, s[20:23], s40 offen offset:0 sc1 lds
    v_fma_f32 v75, v75, v5, v5
    v_rcp_f32 v68, v68
    s_waitcnt lgkmcnt(3)
    v_mfma_f32_32x32x16_bf16 v[112:127], v[200:203], a[44:47], v[112:127]
    ds_read_b128 v[196:199], v7 offset:16384
    v_rcp_f32 v69, v69
    v_rcp_f32 v70, v70
    v_rcp_f32 v71, v71
    v_mfma_f32_32x32x16_bf16 v[112:127], v[204:207], a[48:51], v[112:127]
    ds_read_b128 v[200:203], v7 offset:17408
    buffer_load_dwordx4 v31, s[20:23], s40 offen offset:1024 sc1 lds
    v_rcp_f32 v72, v72
    v_rcp_f32 v73, v73
    s_waitcnt lgkmcnt(3)
    v_mfma_f32_32x32x16_bf16 v[112:127], v[184:187], a[52:55], v[112:127]
    ds_read_b128 v[204:207], v7 offset:18432
    v_rcp_f32 v74, v74
    v_rcp_f32 v75, v75
    v_mul_f32 v232, v232, v68
    v_mfma_f32_32x32x16_bf16 v[112:127], v[188:191], a[56:59], v[112:127]
    ds_read_b128 v[184:187], v7 offset:19456
    buffer_load_dwordx4 v31, s[20:23], s40 offen offset:2048 sc1 lds
    v_mul_f32 v233, v233, v69
    v_mul_f32 v234, v234, v70
    v_mul_f32 v235, v235, v71
    s_waitcnt lgkmcnt(3)
    v_mfma_f32_32x32x16_bf16 v[112:127], v[192:195], a[60:63], v[112:127]
    ds_read_b128 v[188:191], v7 offset:20480
    v_mul_f32 v236, v236, v72
    v_mul_f32 v237, v237, v73
    v_mul_f32 v238, v238, v74
    v_mul_f32 v239, v239, v75
    v_cvt_pk_bf16_f32 v156, v232, v233
    v_mfma_f32_32x32x16_bf16 v[112:127], v[196:199], a[64:67], v[112:127]
    ds_read_b128 v[192:195], v7 offset:21504
    buffer_load_dwordx4 v31, s[20:23], s40 offen offset:3072 sc1 lds
    s_add_u32 s40, s8, 134144
    s_add_u32 m0, s10, 8192
    v_cvt_pk_bf16_f32 v157, v234, v235
    s_waitcnt lgkmcnt(3)
    v_mfma_f32_32x32x16_bf16 v[112:127], v[200:203], a[68:71], v[112:127]
    ds_read_b128 v[196:199], v7 offset:22528
    v_cvt_pk_bf16_f32 v158, v236, v237
    v_cvt_pk_bf16_f32 v159, v238, v239
    buffer_store_dwordx4 v[156:159], v25, s[20:23], s56 offen offset:512 sc1
    s_add_u32 s56, s56, 4096
    v_mul_f32 v68, v6, v240
    v_mfma_f32_32x32x16_bf16 v[112:127], v[204:207], a[72:75], v[112:127]
    ds_read_b128 v[200:203], v7 offset:23552
    v_mul_f32 v69, v6, v241
    v_mul_f32 v70, v6, v242
    v_mul_f32 v71, v6, v243
    v_mul_f32 v72, v6, v244
    s_waitcnt lgkmcnt(3)
    v_mfma_f32_32x32x16_bf16 v[112:127], v[184:187], a[76:79], v[112:127]
    ds_read_b128 v[204:207], v7 offset:24576
    v_mul_f32 v73, v6, v245
    v_mul_f32 v74, v6, v246
    v_mul_f32 v75, v6, v247
    v_exp_f32 v68, v68
    v_mfma_f32_32x32x16_bf16 v[112:127], v[188:191], a[80:83], v[112:127]
    ds_read_b128 v[184:187], v7 offset:25600
    v_exp_f32 v69, v69
    v_exp_f32 v70, v70
    s_waitcnt lgkmcnt(3)
    v_mfma_f32_32x32x16_bf16 v[112:127], v[192:195], a[84:87], v[112:127]
    ds_read_b128 v[188:191], v7 offset:26624
    buffer_load_dwordx4 v31, s[20:23], s40 offen offset:0 sc1 lds
    v_exp_f32 v71, v71
    v_exp_f32 v72, v72
    v_mfma_f32_32x32x16_bf16 v[112:127], v[196:199], a[88:91], v[112:127]
    ds_read_b128 v[192:195], v7 offset:27648
    v_exp_f32 v73, v73
    v_exp_f32 v74, v74
    s_waitcnt lgkmcnt(3)
    v_mfma_f32_32x32x16_bf16 v[112:127], v[200:203], a[92:95], v[112:127]
    ds_read_b128 v[196:199], v7 offset:28672
    buffer_load_dwordx4 v31, s[20:23], s40 offen offset:1024 sc1 lds
    s_add_u32 s40, s9, 166912
    s_cmp_eq_u32 s44, 3
    s_cselect_b32 s40, s40, 0x40000000
    s_cselect_b32 m0, 40960, s3
    v_mfma_f32_32x32x16_bf16 v[112:127], v[204:207], a[96:99], v[112:127]
    ds_read_b128 v[200:203], v7 offset:29696
    v_exp_f32 v75, v75
    v_fma_f32 v68, v68, v5, v5
    v_fma_f32 v69, v69, v5, v5
    s_waitcnt lgkmcnt(3)
    v_mfma_f32_32x32x16_bf16 v[112:127], v[184:187], a[100:103], v[112:127]
    ds_read_b128 v[204:207], v7 offset:30720
    buffer_load_dwordx4 v31, s[20:23], s40 offen sc1 lds
    v_fma_f32 v70, v70, v5, v5
    v_fma_f32 v71, v71, v5, v5
    v_fma_f32 v72, v72, v5, v5
    v_fma_f32 v73, v73, v5, v5
    v_mfma_f32_32x32x16_bf16 v[112:127], v[188:191], a[104:107], v[112:127]
    ds_read_b128 v[184:187], v7 offset:31744
    v_fma_f32 v74, v74, v5, v5
    v_fma_f32 v75, v75, v5, v5
    v_rcp_f32 v68, v68
    s_waitcnt lgkmcnt(3)
    v_mfma_f32_32x32x16_bf16 v[112:127], v[192:195], a[108:111], v[112:127]
    ds_read_b128 v[188:191], v7 offset:32768
    v_rcp_f32 v69, v69
    v_rcp_f32 v70, v70
    v_rcp_f32 v71, v71
    v_mfma_f32_32x32x16_bf16 v[112:127], v[196:199], a[112:115], v[112:127]
    ds_read_b128 v[192:195], v7 offset:33792
    v_rcp_f32 v72, v72
    v_rcp_f32 v73, v73
    s_waitcnt lgkmcnt(3)
    v_mfma_f32_32x32x16_bf16 v[112:127], v[200:203], a[116:119], v[112:127]
    ds_read_b128 v[196:199], v7 offset:34816
    v_rcp_f32 v74, v74
    v_rcp_f32 v75, v75
    v_mul_f32 v240, v240, v68
    v_mfma_f32_32x32x16_bf16 v[112:127], v[204:207], a[120:123], v[112:127]
    ds_read_b128 v[200:203], v7 offset:35840
    v_mul_f32 v241, v241, v69
    v_mul_f32 v242, v242, v70
    v_mul_f32 v243, v243, v71
    v_mul_f32 v244, v244, v72
    s_waitcnt lgkmcnt(3)
    v_mfma_f32_32x32x16_bf16 v[112:127], v[184:187], a[124:127], v[112:127]
    ds_read_b128 v[204:207], v7 offset:36864
    v_mul_f32 v245, v245, v73
    v_mul_f32 v246, v246, v74
    v_mul_f32 v247, v247, v75
    v_cvt_pk_bf16_f32 v152, v240, v241
    v_cvt_pk_bf16_f32 v153, v242, v243
    v_mfma_f32_32x32x16_bf16 v[112:127], v[188:191], a[128:131], v[112:127]
    ds_read_b128 v[184:187], v7 offset:37888
    v_cvt_pk_bf16_f32 v154, v244, v245
    v_cvt_pk_bf16_f32 v155, v246, v247
    buffer_store_dwordx4 v[152:155], v25, s[20:23], s56 offen offset:0 sc1
    v_mul_f32 v68, v6, v248
    s_waitcnt lgkmcnt(3)
    v_mfma_f32_32x32x16_bf16 v[112:127], v[192:195], a[132:135], v[112:127]
    ds_read_b128 v[188:191], v7 offset:38912
    v_mul_f32 v69, v6, v249
    v_mul_f32 v70, v6, v250
    v_mul_f32 v71, v6, v251
    v_mul_f32 v72, v6, v252
    v_mul_f32 v73, v6, v253
    v_mfma_f32_32x32x16_bf16 v[112:127], v[196:199], a[136:139], v[112:127]
    ds_read_b128 v[192:195], v7 offset:39936
    v_mul_f32 v74, v6, v254
    v_mul_f32 v75, v6, v255
    v_exp_f32 v68, v68
    s_waitcnt lgkmcnt(3)
    v_mfma_f32_32x32x16_bf16 v[112:127], v[200:203], a[140:143], v[112:127]
    ds_read_b128 v[196:199], v7 offset:40960
    v_exp_f32 v69, v69
    v_exp_f32 v70, v70
    v_exp_f32 v71, v71
    v_mfma_f32_32x32x16_bf16 v[112:127], v[204:207], a[144:147], v[112:127]
    s_waitcnt vmcnt(16)
    s_barrier
    ds_read_b128 v[200:203], v23 offset:0
    v_exp_f32 v72, v72
    v_exp_f32 v73, v73
    s_waitcnt lgkmcnt(3)
    v_mfma_f32_32x32x16_bf16 v[112:127], v[184:187], a[148:151], v[112:127]
    ds_read_b128 v[204:207], v23 offset:1024
    v_exp_f32 v74, v74
    v_exp_f32 v75, v75
    v_fma_f32 v68, v68, v5, v5
    v_mfma_f32_32x32x16_bf16 v[112:127], v[188:191], a[152:155], v[112:127]
    ds_read_b128 v[184:187], v23 offset:2048
    v_fma_f32 v69, v69, v5, v5
    v_fma_f32 v70, v70, v5, v5
    v_fma_f32 v71, v71, v5, v5
    v_fma_f32 v72, v72, v5, v5
    s_waitcnt lgkmcnt(3)
    v_mfma_f32_32x32x16_bf16 v[112:127], v[192:195], a[156:159], v[112:127]
    ds_read_b128 v[188:191], v23 offset:3072
    v_fma_f32 v73, v73, v5, v5
    v_fma_f32 v74, v74, v5, v5
    v_fma_f32 v75, v75, v5, v5
    v_rcp_f32 v68, v68
    v_mfma_f32_32x32x16_bf16 v[112:127], v[196:199], v[40:43], v[112:127]
    ds_read_b128 v[192:195], v23 offset:4096
    v_rcp_f32 v69, v69
    v_rcp_f32 v70, v70
    s_waitcnt lgkmcnt(3)
    v_mfma_f32_32x32x16_bf16 v[128:143], v[200:203], a[0:3], 0
    ds_read_b128 v[196:199], v23 offset:5120
    v_rcp_f32 v71, v71
    v_rcp_f32 v72, v72
    v_rcp_f32 v73, v73
    v_mfma_f32_32x32x16_bf16 v[128:143], v[204:207], a[4:7], v[128:143]
    ds_read_b128 v[200:203], v23 offset:6144
    v_rcp_f32 v74, v74
    v_rcp_f32 v75, v75
    s_waitcnt lgkmcnt(3)
    v_mfma_f32_32x32x16_bf16 v[128:143], v[184:187], a[8:11], v[128:143]
    ds_read_b128 v[204:207], v23 offset:7168
    v_mul_f32 v248, v248, v68
    v_mul_f32 v249, v249, v69
    v_mul_f32 v250, v250, v70
    v_mul_f32 v251, v251, v71
    v_mul_f32 v252, v252, v72
    v_mfma_f32_32x32x16_bf16 v[128:143], v[188:191], a[12:15], v[128:143]
    s_barrier
    ds_read_b128 v[184:187], v23 offset:8192
    v_mul_f32 v253, v253, v73
    v_mul_f32 v254, v254, v74
    v_mul_f32 v255, v255, v75
    s_waitcnt lgkmcnt(3)
    v_mfma_f32_32x32x16_bf16 v[128:143], v[192:195], a[16:19], v[128:143]
    ds_read_b128 v[188:191], v23 offset:9216
    v_cvt_pk_bf16_f32 v156, v248, v249
    v_cvt_pk_bf16_f32 v157, v250, v251
    v_cvt_pk_bf16_f32 v158, v252, v253
    v_cvt_pk_bf16_f32 v159, v254, v255
    buffer_store_dwordx4 v[156:159], v25, s[20:23], s56 offen offset:512 sc1
    v_mfma_f32_32x32x16_bf16 v[128:143], v[196:199], a[20:23], v[128:143]
    ds_read_b128 v[192:195], v23 offset:10240
    s_add_u32 s45, s12, 15598592
    v_lshlrev_b32 v12, 24, v1
    v_add_u32 v12, s45, v12
    v_and_b32 v8, 7, v1
    s_waitcnt lgkmcnt(3)
    v_mfma_f32_32x32x16_bf16 v[128:143], v[200:203], a[24:27], v[128:143]
    ds_read_b128 v[196:199], v23 offset:11264
    v_add_lshl_u32 v8, s13, v8, 7
    v_add_u32 v27, 15598592, v8
    s_mul_i32 s45, s44, 10496
    s_add_u32 s45, s45, 41984
    v_mul_u32_u24 v5, 328, v22
    v_mfma_f32_32x32x16_bf16 v[128:143], v[204:207], a[28:31], v[128:143]
    ds_read_b128 v[200:203], v23 offset:12288
    v_add_u32 v5, s45, v5
    v_cvt_pk_bf16_f32 v68, v96, v97
    v_cvt_pk_bf16_f32 v69, v98, v99
    v_cvt_pk_bf16_f32 v70, v100, v101
    s_waitcnt lgkmcnt(3)
    v_mfma_f32_32x32x16_bf16 v[128:143], v[184:187], a[32:35], v[128:143]
    ds_read_b128 v[204:207], v23 offset:13312
    v_cvt_pk_bf16_f32 v71, v102, v103
    v_cvt_pk_bf16_f32 v72, v104, v105
    v_cvt_pk_bf16_f32 v73, v106, v107
    v_cvt_pk_bf16_f32 v74, v108, v109
    v_cvt_pk_bf16_f32 v75, v110, v111
    v_mfma_f32_32x32x16_bf16 v[208:223], v[80:83], v[68:71], 0
    s_nop 0
    v_mfma_f32_32x32x16_bf16 v[208:223], v[84:87], v[72:75], v[208:223]
    v_cvt_pk_bf16_f32 v76, v112, v113
    v_cvt_pk_bf16_f32 v77, v114, v115
    v_mov_b32 v78, 0
    v_mov_b32 v79, 0
    v_mfma_f32_32x32x16_bf16 v[224:239], v[88:91], v[72:75], 0
    s_nop 0
    v_mfma_f32_32x32x16_bf16 v[224:239], v[92:95], v[76:79], v[224:239]
    buffer_load_dword v16, v13, s[20:23], 0 offen sc1
    v_lshl_add_u32 v48, v21, 3, v5
    s_nop 2
    v_max3_f32 v44, v208, v209, v210
    v_min3_f32 v45, v208, v209, v210
    v_max3_f32 v44, v44, v211, v212
    v_min3_f32 v45, v45, v211, v212
    v_mfma_f32_32x32x16_bf16 v[128:143], v[188:191], a[36:39], v[128:143]
    ds_read_b128 v[184:187], v23 offset:14336
    v_max3_f32 v44, v44, v213, v214
    v_min3_f32 v45, v45, v213, v214
    v_max3_f32 v44, v44, v215, v216
    v_min3_f32 v45, v45, v215, v216
    s_waitcnt lgkmcnt(3)
    v_mfma_f32_32x32x16_bf16 v[128:143], v[192:195], a[40:43], v[128:143]
    ds_read_b128 v[188:191], v23 offset:15360
    v_max_f32 v44, v44, v217
    v_min_f32 v45, v45, v217
    v_mov_b32 v46, v44
    v_mov_b32 v47, v45
    s_nop 0
    v_mfma_f32_32x32x16_bf16 v[128:143], v[196:199], a[44:47], v[128:143]
    ds_read_b128 v[192:195], v23 offset:16384
    v_permlane32_swap_b32 v44, v46
    v_permlane32_swap_b32 v45, v47
    v_max_f32 v44, v44, v46
    v_min_f32 v45, v45, v47
    s_waitcnt lgkmcnt(3)
    v_mfma_f32_32x32x16_bf16 v[128:143], v[200:203], a[48:51], v[128:143]
    ds_read_b128 v[196:199], v23 offset:17408
    v_mul_f32 v44, v6, v44
    v_mul_f32 v45, v6, v45
    v_fma_f32 v68, -v208, v6, v44
    v_fma_f32 v208, v208, v6, -v45
    v_fma_f32 v69, -v209, v6, v44
    v_mfma_f32_32x32x16_bf16 v[128:143], v[204:207], a[52:55], v[128:143]
    ds_read_b128 v[200:203], v23 offset:18432
    v_fma_f32 v209, v209, v6, -v45
    v_fma_f32 v70, -v210, v6, v44
    v_fma_f32 v210, v210, v6, -v45
    v_fma_f32 v71, -v211, v6, v44
    s_waitcnt lgkmcnt(3)
    v_mfma_f32_32x32x16_bf16 v[128:143], v[184:187], a[56:59], v[128:143]
    ds_read_b128 v[204:207], v23 offset:19456
    v_fma_f32 v211, v211, v6, -v45
    v_fma_f32 v72, -v212, v6, v44
    v_fma_f32 v212, v212, v6, -v45
    v_fma_f32 v73, -v213, v6, v44
    v_fma_f32 v213, v213, v6, -v45
    v_mfma_f32_32x32x16_bf16 v[128:143], v[188:191], a[60:63], v[128:143]
    ds_read_b128 v[184:187], v23 offset:20480
    v_fma_f32 v74, -v214, v6, v44
    v_fma_f32 v214, v214, v6, -v45
    v_fma_f32 v75, -v215, v6, v44
    v_fma_f32 v215, v215, v6, -v45
    s_waitcnt lgkmcnt(3)
    v_mfma_f32_32x32x16_bf16 v[128:143], v[192:195], a[64:67], v[128:143]
    ds_read_b128 v[188:191], v23 offset:21504
    v_fma_f32 v76, -v216, v6, v44
    v_fma_f32 v216, v216, v6, -v45
    v_fma_f32 v77, -v217, v6, v44
    v_fma_f32 v217, v217, v6, -v45
    v_exp_f32 v68, v68
    v_mfma_f32_32x32x16_bf16 v[128:143], v[196:199], a[68:71], v[128:143]
    ds_read_b128 v[192:195], v23 offset:22528
    v_exp_f32 v208, v208
    v_exp_f32 v69, v69
    s_waitcnt lgkmcnt(3)
    v_mfma_f32_32x32x16_bf16 v[128:143], v[200:203], a[72:75], v[128:143]
    ds_read_b128 v[196:199], v23 offset:23552
    v_exp_f32 v209, v209
    v_exp_f32 v70, v70
    v_exp_f32 v210, v210
    v_mfma_f32_32x32x16_bf16 v[128:143], v[204:207], a[76:79], v[128:143]
    ds_read_b128 v[200:203], v23 offset:24576
    v_exp_f32 v71, v71
    v_exp_f32 v211, v211
    s_waitcnt lgkmcnt(3)
    v_mfma_f32_32x32x16_bf16 v[128:143], v[184:187], a[80:83], v[128:143]
    ds_read_b128 v[204:207], v23 offset:25600
    v_exp_f32 v72, v72
    v_exp_f32 v212, v212
    v_exp_f32 v73, v73
    v_mfma_f32_32x32x16_bf16 v[128:143], v[188:191], a[84:87], v[128:143]
    ds_read_b128 v[184:187], v23 offset:26624
    v_exp_f32 v213, v213
    v_exp_f32 v74, v74
    s_waitcnt lgkmcnt(3)
    v_mfma_f32_32x32x16_bf16 v[128:143], v[192:195], a[88:91], v[128:143]
    ds_read_b128 v[188:191], v23 offset:27648
    v_exp_f32 v214, v214
    v_exp_f32 v75, v75
    v_exp_f32 v215, v215
    v_mfma_f32_32x32x16_bf16 v[128:143], v[196:199], a[92:95], v[128:143]
    ds_read_b128 v[192:195], v23 offset:28672
    v_exp_f32 v76, v76
    v_exp_f32 v216, v216
    s_waitcnt lgkmcnt(3)
    v_mfma_f32_32x32x16_bf16 v[128:143], v[200:203], a[96:99], v[128:143]
    ds_read_b128 v[196:199], v23 offset:29696
    v_exp_f32 v77, v77
    v_exp_f32 v217, v217
    v_add_f32 v46, v68, v69
    v_mfma_f32_32x32x16_bf16 v[128:143], v[204:207], a[100:103], v[128:143]
    ds_read_b128 v[200:203], v23 offset:30720
    v_add_f32 v47, v208, v209
    v_add_f32 v46, v46, v70
    v_add_f32 v47, v47, v210
    v_add_f32 v46, v46, v71
    s_waitcnt lgkmcnt(3)
    v_mfma_f32_32x32x16_bf16 v[128:143], v[184:187], a[104:107], v[128:143]
    ds_read_b128 v[204:207], v23 offset:31744
    v_add_f32 v47, v47, v211
    v_add_f32 v46, v46, v72
    v_add_f32 v47, v47, v212
    v_add_f32 v46, v46, v73
    v_add_f32 v47, v47, v213
    v_mfma_f32_32x32x16_bf16 v[128:143], v[188:191], a[108:111], v[128:143]
    ds_read_b128 v[184:187], v23 offset:32768
    v_add_f32 v46, v46, v74
    v_add_f32 v47, v47, v214
    v_add_f32 v46, v46, v75
    v_add_f32 v47, v47, v215
    s_waitcnt lgkmcnt(3)
    v_mfma_f32_32x32x16_bf16 v[128:143], v[192:195], a[112:115], v[128:143]
    ds_read_b128 v[188:191], v23 offset:33792
    v_add_f32 v46, v46, v76
    v_add_f32 v47, v47, v216
    v_add_f32 v46, v46, v77
    v_add_f32 v47, v47, v217
    v_mov_b32 v44, v46
    v_mfma_f32_32x32x16_bf16 v[128:143], v[196:199], a[116:119], v[128:143]
    ds_read_b128 v[192:195], v23 offset:34816
    v_mov_b32 v45, v47
    s_nop 0
    v_permlane32_swap_b32 v46, v44
    v_permlane32_swap_b32 v47, v45
    s_waitcnt lgkmcnt(3)
    v_mfma_f32_32x32x16_bf16 v[128:143], v[200:203], a[120:123], v[128:143]
    ds_read_b128 v[196:199], v23 offset:35840
    v_add_f32 v46, v46, v44
    v_add_f32 v47, v47, v45
    v_rcp_f32 v46, v46
    v_rcp_f32 v47, v47
    v_mfma_f32_32x32x16_bf16 v[128:143], v[204:207], a[124:127], v[128:143]
    ds_read_b128 v[200:203], v23 offset:36864
    v_mul_f32 v68, v46, v68
    v_mul_f32 v208, v47, v208
    v_mul_f32 v69, v46, v69
    v_mul_f32 v209, v47, v209
    s_waitcnt lgkmcnt(3)
    v_mfma_f32_32x32x16_bf16 v[128:143], v[184:187], a[128:131], v[128:143]
    ds_read_b128 v[204:207], v23 offset:37888
    v_mul_f32 v70, v46, v70
    v_mul_f32 v210, v47, v210
    v_mul_f32 v71, v46, v71
    v_mul_f32 v211, v47, v211
    v_mul_f32 v72, v46, v72
    v_mfma_f32_32x32x16_bf16 v[128:143], v[188:191], a[132:135], v[128:143]
    ds_read_b128 v[184:187], v23 offset:38912
    v_mul_f32 v212, v47, v212
    v_mul_f32 v73, v46, v73
    v_mul_f32 v213, v47, v213
    v_mul_f32 v74, v46, v74
    s_waitcnt lgkmcnt(3)
    v_mfma_f32_32x32x16_bf16 v[128:143], v[192:195], a[136:139], v[128:143]
    ds_read_b128 v[188:191], v23 offset:39936
    v_mul_f32 v214, v47, v214
    v_mul_f32 v75, v46, v75
    v_mul_f32 v215, v47, v215
    v_mul_f32 v76, v46, v76
    v_mul_f32 v216, v47, v216
    v_mfma_f32_32x32x16_bf16 v[128:143], v[196:199], a[140:143], v[128:143]
    ds_read_b128 v[192:195], v23 offset:40960
    v_mul_f32 v77, v46, v77
    v_mul_f32 v217, v47, v217
    v_cvt_pk_bf16_f32 v160, v68, v69
    v_cvt_pk_bf16_f32 v164, v208, v209
    s_waitcnt lgkmcnt(3)
    v_mfma_f32_32x32x16_bf16 v[128:143], v[200:203], a[144:147], v[128:143]
    s_waitcnt vmcnt(3)
    s_barrier
    ds_read_b128 v[196:199], v2 offset:0
    v_cvt_pk_bf16_f32 v161, v70, v71
    v_cvt_pk_bf16_f32 v165, v210, v211
    v_cvt_pk_bf16_f32 v162, v72, v73
    v_cvt_pk_bf16_f32 v166, v212, v213
    v_mfma_f32_32x32x16_bf16 v[128:143], v[204:207], a[148:151], v[128:143]
    ds_read_b128 v[200:203], v2 offset:1024
    v_cvt_pk_bf16_f32 v163, v74, v75
    v_cvt_pk_bf16_f32 v167, v214, v215
    v_cvt_pk_bf16_f32 v168, v76, v77
    v_cvt_pk_bf16_f32 v169, v216, v217
    s_waitcnt lgkmcnt(3)
    v_mfma_f32_32x32x16_bf16 v[128:143], v[184:187], a[152:155], v[128:143]
    ds_read_b128 v[204:207], v2 offset:2048
    ds_write_b64 v48, v[160:161] offset:0
    ds_write_b64 v48, v[162:163] offset:16
    ds_write_b64 v48, v[164:165] offset:32
    ds_write_b64 v48, v[166:167] offset:48
    ds_write_b64 v48, v[168:169] offset:64
    v_mfma_f32_32x32x16_bf16 v[128:143], v[188:191], a[156:159], v[128:143]
    ds_read_b128 v[184:187], v2 offset:3072
    s_waitcnt vmcnt(1)
    buffer_store_dword v11, v12, s[20:23], 0 offen sc1
    v_max3_f32 v44, v224, v225, v226
    v_min3_f32 v45, v224, v225, v226
    v_max3_f32 v44, v44, v227, v228
    s_waitcnt lgkmcnt(8)
    v_mfma_f32_32x32x16_bf16 v[128:143], v[192:195], v[40:43], v[128:143]
    ds_read_b128 v[188:191], v2 offset:4096
    v_min3_f32 v45, v45, v227, v228
    v_max3_f32 v44, v44, v229, v230
    v_min3_f32 v45, v45, v229, v230
    v_max3_f32 v44, v44, v231, v232
    v_min3_f32 v45, v45, v231, v232
    v_mfma_f32_32x32x16_bf16 v[144:159], v[196:199], a[0:3], 0
    ds_read_b128 v[192:195], v2 offset:5120
    v_max_f32 v44, v44, v233
    v_min_f32 v45, v45, v233
    v_mov_b32 v46, v44
    v_mov_b32 v47, v45
    s_waitcnt lgkmcnt(8)
    v_mfma_f32_32x32x16_bf16 v[144:159], v[200:203], a[4:7], v[144:159]
    ds_read_b128 v[196:199], v2 offset:6144
    s_nop 0
    v_permlane32_swap_b32 v44, v46
    v_permlane32_swap_b32 v45, v47
    v_max_f32 v44, v44, v46
    v_min_f32 v45, v45, v47
    v_mfma_f32_32x32x16_bf16 v[144:159], v[204:207], a[8:11], v[144:159]
    ds_read_b128 v[200:203], v2 offset:7168
    v_mul_f32 v44, v6, v44
    v_mul_f32 v45, v6, v45
    v_fma_f32 v68, -v224, v6, v44
    v_fma_f32 v224, v224, v6, -v45
    s_waitcnt lgkmcnt(3)
    v_mfma_f32_32x32x16_bf16 v[144:159], v[184:187], a[12:15], v[144:159]
    ds_read_b128 v[204:207], v2 offset:8192
    v_fma_f32 v69, -v225, v6, v44
    v_fma_f32 v225, v225, v6, -v45
    v_fma_f32 v70, -v226, v6, v44
    v_fma_f32 v226, v226, v6, -v45
    v_fma_f32 v71, -v227, v6, v44
    v_mfma_f32_32x32x16_bf16 v[144:159], v[188:191], a[16:19], v[144:159]
    ds_read_b128 v[184:187], v2 offset:9216
    v_fma_f32 v227, v227, v6, -v45
    v_fma_f32 v72, -v228, v6, v44
    v_fma_f32 v228, v228, v6, -v45
    v_fma_f32 v73, -v229, v6, v44
    s_waitcnt lgkmcnt(3)
    v_mfma_f32_32x32x16_bf16 v[144:159], v[192:195], a[20:23], v[144:159]
    ds_read_b128 v[188:191], v2 offset:10240
    v_fma_f32 v229, v229, v6, -v45
    v_fma_f32 v74, -v230, v6, v44
    v_fma_f32 v230, v230, v6, -v45
    v_fma_f32 v75, -v231, v6, v44
    v_fma_f32 v231, v231, v6, -v45
    v_mfma_f32_32x32x16_bf16 v[144:159], v[196:199], a[24:27], v[144:159]
    ds_read_b128 v[192:195], v2 offset:11264
    v_fma_f32 v76, -v232, v6, v44
    v_fma_f32 v232, v232, v6, -v45
    v_fma_f32 v77, -v233, v6, v44
    v_fma_f32 v233, v233, v6, -v45
    s_waitcnt lgkmcnt(3)
    v_mfma_f32_32x32x16_bf16 v[144:159], v[200:203], a[28:31], v[144:159]
    ds_read_b128 v[196:199], v2 offset:12288
    v_exp_f32 v68, v68
    v_exp_f32 v224, v224
    v_exp_f32 v69, v69
    v_mfma_f32_32x32x16_bf16 v[144:159], v[204:207], a[32:35], v[144:159]
    ds_read_b128 v[200:203], v2 offset:13312
    v_exp_f32 v225, v225
    v_exp_f32 v70, v70
    s_waitcnt lgkmcnt(3)
    v_mfma_f32_32x32x16_bf16 v[144:159], v[184:187], a[36:39], v[144:159]
    ds_read_b128 v[204:207], v2 offset:14336
    v_exp_f32 v226, v226
    v_exp_f32 v71, v71
    v_exp_f32 v227, v227
    v_mfma_f32_32x32x16_bf16 v[144:159], v[188:191], a[40:43], v[144:159]
    ds_read_b128 v[184:187], v2 offset:15360
    v_exp_f32 v72, v72
    v_exp_f32 v228, v228
    s_waitcnt lgkmcnt(3)
    v_mfma_f32_32x32x16_bf16 v[144:159], v[192:195], a[44:47], v[144:159]
    ds_read_b128 v[188:191], v2 offset:16384
    v_exp_f32 v73, v73
    v_exp_f32 v229, v229
    v_exp_f32 v74, v74
    v_mfma_f32_32x32x16_bf16 v[144:159], v[196:199], a[48:51], v[144:159]
    ds_read_b128 v[192:195], v2 offset:17408
    v_exp_f32 v230, v230
    v_exp_f32 v75, v75
    s_waitcnt lgkmcnt(3)
    v_mfma_f32_32x32x16_bf16 v[144:159], v[200:203], a[52:55], v[144:159]
    ds_read_b128 v[196:199], v2 offset:18432
    v_exp_f32 v231, v231
    v_exp_f32 v76, v76
    v_exp_f32 v232, v232
    v_mfma_f32_32x32x16_bf16 v[144:159], v[204:207], a[56:59], v[144:159]
    ds_read_b128 v[200:203], v2 offset:19456
    v_exp_f32 v77, v77
    v_exp_f32 v233, v233
    s_waitcnt lgkmcnt(3)
    v_mfma_f32_32x32x16_bf16 v[144:159], v[184:187], a[60:63], v[144:159]
    ds_read_b128 v[204:207], v2 offset:20480
    v_add_f32 v46, v68, v69
    v_add_f32 v47, v224, v225
    v_add_f32 v46, v46, v70
    v_add_f32 v47, v47, v226
    v_add_f32 v46, v46, v71
    v_mfma_f32_32x32x16_bf16 v[144:159], v[188:191], a[64:67], v[144:159]
    ds_read_b128 v[184:187], v2 offset:21504
    v_add_f32 v47, v47, v227
    v_add_f32 v46, v46, v72
    v_add_f32 v47, v47, v228
    v_add_f32 v46, v46, v73
    s_waitcnt lgkmcnt(3)
    v_mfma_f32_32x32x16_bf16 v[144:159], v[192:195], a[68:71], v[144:159]
    ds_read_b128 v[188:191], v2 offset:22528
    v_add_f32 v47, v47, v229
    v_add_f32 v46, v46, v74
    v_add_f32 v47, v47, v230
    v_add_f32 v46, v46, v75
    v_add_f32 v47, v47, v231
    v_mfma_f32_32x32x16_bf16 v[144:159], v[196:199], a[72:75], v[144:159]
    ds_read_b128 v[192:195], v2 offset:23552
    v_add_f32 v46, v46, v76
    v_add_f32 v47, v47, v232
    v_add_f32 v46, v46, v77
    v_add_f32 v47, v47, v233
    s_waitcnt lgkmcnt(3)
    v_mfma_f32_32x32x16_bf16 v[144:159], v[200:203], a[76:79], v[144:159]
    ds_read_b128 v[196:199], v2 offset:24576
    v_mov_b32 v44, v46
    v_mov_b32 v45, v47
    s_nop 0
    v_permlane32_swap_b32 v46, v44
    v_permlane32_swap_b32 v47, v45
    v_mfma_f32_32x32x16_bf16 v[144:159], v[204:207], a[80:83], v[144:159]
    ds_read_b128 v[200:203], v2 offset:25600
    v_add_f32 v46, v46, v44
    v_add_f32 v47, v47, v45
    v_rcp_f32 v46, v46
    s_waitcnt lgkmcnt(3)
    v_mfma_f32_32x32x16_bf16 v[144:159], v[184:187], a[84:87], v[144:159]
    ds_read_b128 v[204:207], v2 offset:26624
    v_rcp_f32 v47, v47
    v_mul_f32 v68, v46, v68
    v_mul_f32 v224, v47, v224
    v_mul_f32 v69, v46, v69
    v_mfma_f32_32x32x16_bf16 v[144:159], v[188:191], a[88:91], v[144:159]
    ds_read_b128 v[184:187], v2 offset:27648
    v_mul_f32 v225, v47, v225
    v_mul_f32 v70, v46, v70
    v_mul_f32 v226, v47, v226
    v_mul_f32 v71, v46, v71
    s_waitcnt lgkmcnt(3)
    v_mfma_f32_32x32x16_bf16 v[144:159], v[192:195], a[92:95], v[144:159]
    ds_read_b128 v[188:191], v2 offset:28672
    v_mul_f32 v227, v47, v227
    v_mul_f32 v72, v46, v72
    v_mul_f32 v228, v47, v228
    v_mul_f32 v73, v46, v73
    v_mul_f32 v229, v47, v229
    v_mfma_f32_32x32x16_bf16 v[144:159], v[196:199], a[96:99], v[144:159]
    ds_read_b128 v[192:195], v2 offset:29696
    v_mul_f32 v74, v46, v74
    v_mul_f32 v230, v47, v230
    v_mul_f32 v75, v46, v75
    v_mul_f32 v231, v47, v231
    s_waitcnt lgkmcnt(3)
    v_mfma_f32_32x32x16_bf16 v[144:159], v[200:203], a[100:103], v[144:159]
    ds_read_b128 v[196:199], v2 offset:30720
    v_mul_f32 v76, v46, v76
    v_mul_f32 v232, v47, v232
    v_mul_f32 v77, v46, v77
    v_mul_f32 v233, v47, v233
    v_cvt_pk_bf16_f32 v172, v68, v69
    v_mfma_f32_32x32x16_bf16 v[144:159], v[204:207], a[104:107], v[144:159]
    ds_read_b128 v[200:203], v2 offset:31744
    v_cvt_pk_bf16_f32 v176, v224, v225
    v_cvt_pk_bf16_f32 v173, v70, v71
    v_cvt_pk_bf16_f32 v177, v226, v227
    v_cvt_pk_bf16_f32 v174, v72, v73
    s_waitcnt lgkmcnt(3)
    v_mfma_f32_32x32x16_bf16 v[144:159], v[184:187], a[108:111], v[144:159]
    ds_read_b128 v[204:207], v2 offset:32768
    v_cvt_pk_bf16_f32 v178, v228, v229
    v_cvt_pk_bf16_f32 v175, v74, v75
    v_cvt_pk_bf16_f32 v179, v230, v231
    v_cvt_pk_bf16_f32 v180, v76, v77
    v_cvt_pk_bf16_f32 v181, v232, v233
    v_mfma_f32_32x32x16_bf16 v[144:159], v[188:191], a[112:115], v[144:159]
    ds_read_b128 v[184:187], v2 offset:33792
    ds_write_b64 v48, v[172:173] offset:80
    ds_write_b64 v48, v[174:175] offset:96
    ds_write_b64 v48, v[176:177] offset:112
    ds_write_b64 v48, v[178:179] offset:128
    s_waitcnt lgkmcnt(7)
    v_mfma_f32_32x32x16_bf16 v[144:159], v[192:195], a[116:119], v[144:159]
    ds_read_b128 v[188:191], v2 offset:34816
    ds_write_b64 v48, v[180:181] offset:144
    s_waitcnt vmcnt(1)
    v_cmp_ne_u32 vcc, s47, v16
    s_nop 4
    s_cbranch_vccnz Lpoll3
Lpoll3_ret:
    v_mad_i32_i24 v49, v21, 16, v5
    s_add_u32 s40, s14, 2686976
    v_mfma_f32_32x32x16_bf16 v[144:159], v[196:199], a[120:123], v[144:159]
    ds_read_b128 v[192:195], v2 offset:35840
    buffer_load_dwordx4 a[160:163], v2, s[20:23], s40 offen offset:0 sc1
    buffer_load_dwordx4 a[164:167], v2, s[20:23], s40 offen offset:1024 sc1
    v_mad_i32_i24 v50, v21, 32, v5
    v_mad_i32_i24 v51, v21, -8, v5
    s_waitcnt lgkmcnt(8)
    v_mfma_f32_32x32x16_bf16 v[144:159], v[200:203], a[124:127], v[144:159]
    ds_read_b128 v[196:199], v2 offset:36864
    v_mad_i32_i24 v52, v21, 8, v5
    v_mul_f32 v116, v4, v116
    v_mul_f32 v117, v4, v117
    v_mul_f32 v118, v4, v118
    v_mul_f32 v119, v4, v119
    v_mfma_f32_32x32x16_bf16 v[144:159], v[204:207], a[128:131], v[144:159]
    ds_read_b128 v[200:203], v2 offset:37888
    v_cvt_pk_bf16_f32 v68, v116, v117
    v_cvt_pk_bf16_f32 v69, v118, v119
    buffer_load_dwordx4 a[168:171], v2, s[20:23], s40 offen offset:2048 sc1
    ds_write_b64 v49, v[68:69] offset:160
    s_waitcnt lgkmcnt(5)
    v_mfma_f32_32x32x16_bf16 v[144:159], v[184:187], a[132:135], v[144:159]
    v_mul_f32 v120, v4, v120
    v_mul_f32 v121, v4, v121
    v_mul_f32 v122, v4, v122
    v_mul_f32 v123, v4, v123
    v_cvt_pk_bf16_f32 v70, v120, v121
    v_cvt_pk_bf16_f32 v71, v122, v123
    ds_write_b64 v49, v[70:71] offset:168
    v_mul_f32 v124, v4, v124
    v_mul_f32 v125, v4, v125
    v_mul_f32 v126, v4, v126
    v_mul_f32 v127, v4, v127
    v_cvt_pk_bf16_f32 v72, v124, v125
    v_cvt_pk_bf16_f32 v73, v126, v127
    buffer_load_dwordx4 a[172:175], v2, s[20:23], s40 offen offset:3072 sc1
    ds_write_b64 v50, v[72:73] offset:192
    v_mul_f32 v128, v4, v128
    v_mul_f32 v129, v4, v129
    v_mul_f32 v130, v4, v130
    v_mul_f32 v131, v4, v131
    v_cvt_pk_bf16_f32 v74, v128, v129
    v_cvt_pk_bf16_f32 v75, v130, v131
    ds_write_b64 v51, v[74:75] offset:240
    v_mul_f32 v132, v4, v132
    v_mul_f32 v133, v4, v133
    v_mul_f32 v134, v4, v134
    v_mul_f32 v135, v4, v135
    v_cvt_pk_bf16_f32 v76, v132, v133
    v_cvt_pk_bf16_f32 v77, v134, v135
    ds_write_b64 v52, v[76:77] offset:248
    v_mov_b32 v78, 0x3f80
    v_mov_b32 v79, 0
    buffer_load_dwordx4 a[176:179], v26, s[20:23], s40 offen offset:0 sc1
    s_add_u32 s40, s14, 2692096
    ds_write_b64 v52, v[78:79] offset:200
    ds_write_b64 v52, v[78:79] offset:264
    v_lshl_add_u32 v8, v21, 3, v15
    v_mul_u32_u24 v8, 328, v8
    v_and_b32 v9, 1, v14
    v_lshl_add_u32 v8, v9, 5, v8
    v_lshl_add_u32 v8, v20, 3, v8
    s_lshr_b32 s18, s44, 1
    s_mul_i32 s46, s18, 80
    s_bitcmp1_b32 s44, 0
    s_cselect_b32 s55, 64, 0
    s_add_u32 s46, s46, s55
    s_add_u32 s46, s46, 41984
    v_add_u32 v53, s46, v8
    s_lshl_b32 s46, s18, 6
    buffer_load_dwordx4 a[180:183], v2, s[20:23], s40 offen offset:0 sc1
    s_add_u32 s46, s46, 42144
    v_add_u32 v54, s46, v8
    v_cmp_eq_u32 vcc, 24, v22
    s_waitcnt lgkmcnt(0)
    s_barrier
    ds_read_b64_tr_b16 a[0:1], v53 offset:0
    ds_read_b64_tr_b16 a[2:3], v53 offset:1312
    ds_read_b64_tr_b16 a[4:5], v54 offset:0
    ds_read_b64_tr_b16 a[6:7], v54 offset:1312
    ds_read_b128 v[204:207], v2 offset:38912
    v_mfma_f32_32x32x16_bf16 v[144:159], v[188:191], a[136:139], v[144:159]
    ds_read_b64_tr_b16 a[8:9], v53 offset:5248
    ds_read_b64_tr_b16 a[10:11], v53 offset:6560
    ds_read_b64_tr_b16 a[12:13], v54 offset:5248
    ds_read_b64_tr_b16 a[14:15], v54 offset:6560
    ds_read_b128 v[184:187], v2 offset:39936
    v_mfma_f32_32x32x16_bf16 v[144:159], v[192:195], a[140:143], v[144:159]
    ds_read_b64_tr_b16 a[16:17], v53 offset:10496
    ds_read_b64_tr_b16 a[18:19], v53 offset:11808
    ds_read_b64_tr_b16 a[20:21], v54 offset:10496
    ds_read_b64_tr_b16 a[22:23], v54 offset:11808
    ds_read_b128 v[188:191], v2 offset:40960
    buffer_load_dwordx4 a[184:187], v2, s[20:23], s40 offen offset:1024 sc1
    v_mfma_f32_32x32x16_bf16 v[144:159], v[196:199], a[144:147], v[144:159]
    ds_read_b64_tr_b16 a[24:25], v53 offset:15744
    ds_read_b64_tr_b16 a[26:27], v53 offset:17056
    ds_read_b64_tr_b16 a[28:29], v54 offset:15744
    ds_read_b64_tr_b16 a[30:31], v54 offset:17056
    v_cndmask_b32 v8, v22, 21, vcc
    v_mad_u32_u24 v9, v21, 22, v8
    buffer_load_dwordx4 a[188:191], v2, s[20:23], s40 offen offset:2048 sc1
    v_cmp_gt_u32 vcc, 22, v8
    s_waitcnt lgkmcnt(14)
    v_mfma_f32_32x32x16_bf16 v[144:159], v[200:203], a[148:151], v[144:159]
    ds_read_b64_tr_b16 a[32:33], v53 offset:20992
    ds_read_b64_tr_b16 a[34:35], v53 offset:22304
    ds_read_b64_tr_b16 a[36:37], v54 offset:20992
    ds_read_b64_tr_b16 a[38:39], v54 offset:22304
    v_cmp_ne_u32 s[42:43], 21, v22
    s_nop 0
    s_and_b64 vcc, vcc, s[42:43]
    v_mfma_f32_32x32x16_bf16 v[144:159], v[204:207], a[152:155], v[144:159]
    ds_read_b64_tr_b16 a[40:41], v53 offset:26240
    ds_read_b64_tr_b16 a[42:43], v53 offset:27552
    ds_read_b64_tr_b16 a[44:45], v54 offset:26240
    ds_read_b64_tr_b16 a[46:47], v54 offset:27552
    v_mov_b32 v10, 0x8000000
    s_waitcnt lgkmcnt(12)
    v_mfma_f32_32x32x16_bf16 v[144:159], v[184:187], a[156:159], v[144:159]
    ds_read_b64_tr_b16 a[48:49], v53 offset:31488
    ds_read_b64_tr_b16 a[50:51], v53 offset:32800
    ds_read_b64_tr_b16 a[52:53], v54 offset:31488
    ds_read_b64_tr_b16 a[54:55], v54 offset:32800
    buffer_load_dwordx4 a[192:195], v2, s[20:23], s40 offen offset:3072 sc1
    v_cndmask_b32 v25, v10, v9, vcc
    v_mfma_f32_32x32x16_bf16 v[144:159], v[188:191], v[40:43], v[144:159]
    ds_read_b64_tr_b16 a[56:57], v53 offset:36736
    ds_read_b64_tr_b16 a[58:59], v53 offset:38048
    ds_read_b64_tr_b16 a[60:61], v54 offset:36736
    ds_read_b64_tr_b16 a[62:63], v54 offset:38048
    s_lshl1_add_u32 s19, s50, s18
    v_mfma_f32_32x32x16_bf16 v[96:111], a[0:3], a[4:7], 0
    buffer_load_dwordx4 a[196:199], v26, s[20:23], s40 offen offset:0 sc1
    s_add_u32 s40, s14, 2697216
    s_lshl4_add_u32 s46, s19, s49
    s_mul_i32 s55, s46, 1792
    s_add_u32 s55, s55, 14385152
    s_bitcmp1_b32 s44, 0
    s_cselect_b32 s56, 0x40000000, s55
    s_cselect_b32 s55, s55, 0x40000000
    v_mfma_f32_32x32x16_bf16 v[96:111], a[8:11], a[12:15], v[96:111]
    v_lshlrev_b32 v29, 4, v25
    v_lshlrev_b32 v30, 3, v25
    s_and_b32 s45, s44, 1
    s_lshl1_add_u32 s46, s46, s45
    s_lshl_b32 s46, s46, 7
    s_add_u32 s46, s46, 15860736
    v_mfma_f32_32x32x16_bf16 v[96:111], a[16:19], a[20:23], v[96:111]
    buffer_load_dwordx4 a[200:203], v2, s[20:23], s40 offen offset:0 sc1
    v_lshlrev_b32 v12, 24, v1
    v_add_u32 v12, s46, v12
    s_lshl_b32 s46, s19, 5
    s_lshl4_add_u32 s46, s45, s46
    v_and_b32 v8, 15, v1
    s_waitcnt lgkmcnt(15)
    v_mfma_f32_32x32x16_bf16 v[96:111], a[24:27], a[28:31], v[96:111]
    v_add_u32 v8, s46, v8
    v_lshlrev_b32 v8, 7, v8
    v_add_u32 v13, 15860736, v8
    s_waitcnt lgkmcnt(12)
    v_mfma_f32_32x32x16_bf16 v[96:111], a[32:35], a[36:39], v[96:111]
    buffer_load_dwordx4 a[204:207], v2, s[20:23], s40 offen offset:1024 sc1
    s_waitcnt lgkmcnt(8)
    v_mfma_f32_32x32x16_bf16 v[96:111], a[40:43], a[44:47], v[96:111]
    s_waitcnt lgkmcnt(4)
    v_mfma_f32_32x32x16_bf16 v[96:111], a[48:51], a[52:55], v[96:111]
    buffer_load_dwordx4 a[208:211], v2, s[20:23], s40 offen offset:2048 sc1
    s_waitcnt lgkmcnt(0)
    v_mfma_f32_32x32x16_bf16 v[96:111], a[56:59], a[60:63], v[96:111]
    s_nop 11
    v_cvt_pk_bf16_f32 v128, v96, v97
    buffer_load_dwordx4 a[212:215], v2, s[20:23], s40 offen offset:3072 sc1
    v_cvt_pk_bf16_f32 v129, v98, v99
    v_cvt_pk_bf16_f32 v130, v100, v101
    v_cvt_pk_bf16_f32 v131, v102, v103
    v_cvt_pk_bf16_f32 v132, v104, v105
    v_cvt_pk_bf16_f32 v133, v106, v107
    v_cvt_pk_bf16_f32 v134, v108, v109
    v_cvt_pk_bf16_f32 v135, v110, v111
    buffer_store_dwordx4 v[128:131], v29, s[20:23], s56 offen sc1
    buffer_store_dwordx4 v[132:135], v29, s[20:23], s56 offen offset:704 sc1
    buffer_store_dwordx2 v[128:129], v30, s[20:23], s55 offen offset:1408 sc1
    buffer_load_dword v28, v27, s[20:23], 0 offen sc1
    v_cvt_pk_bf16_f32 v68, v136, v137
    v_cvt_pk_bf16_f32 v69, v138, v139
    v_cvt_pk_bf16_f32 v70, v140, v141
    v_cvt_pk_bf16_f32 v71, v142, v143
    v_cvt_pk_bf16_f32 v72, v144, v145
    v_cvt_pk_bf16_f32 v73, v146, v147
    v_cvt_pk_bf16_f32 v74, v148, v149
    v_cvt_pk_bf16_f32 v75, v150, v151
    v_mfma_f32_32x32x16_bf16 v[96:111], v[80:83], v[68:71], 0
    s_nop 0
    v_mfma_f32_32x32x16_bf16 v[96:111], v[84:87], v[72:75], v[96:111]
    v_cvt_pk_bf16_f32 v76, v152, v153
    v_cvt_pk_bf16_f32 v77, v154, v155
    v_mov_b32 v78, 0
    v_mov_b32 v79, 0
    buffer_load_dwordx4 a[216:219], v26, s[20:23], s40 offen offset:0 sc1
    v_mfma_f32_32x32x16_bf16 v[112:127], v[88:91], v[72:75], 0
    s_add_u32 s40, s14, 2702336
    v_mfma_f32_32x32x16_bf16 v[112:127], v[92:95], v[76:79], v[112:127]
    buffer_load_dwordx4 a[220:223], v2, s[20:23], s40 offen offset:0 sc1
    buffer_load_dwordx4 a[224:227], v2, s[20:23], s40 offen offset:1024 sc1
    buffer_load_dwordx4 a[228:231], v2, s[20:23], s40 offen offset:2048 sc1
    buffer_load_dwordx4 a[232:235], v2, s[20:23], s40 offen offset:3072 sc1
    buffer_load_dwordx4 a[236:239], v26, s[20:23], s40 offen offset:0 sc1
    s_add_u32 s40, s14, 2707456
    buffer_load_dwordx4 a[240:243], v2, s[20:23], s40 offen offset:0 sc1
    buffer_load_dwordx4 a[244:247], v2, s[20:23], s40 offen offset:1024 sc1
    buffer_load_dwordx4 a[248:251], v2, s[20:23], s40 offen offset:2048 sc1
    buffer_load_dwordx4 a[252:255], v2, s[20:23], s40 offen offset:3072 sc1
    buffer_load_dwordx4 a[64:67], v26, s[20:23], s40 offen offset:0 sc1
    s_add_u32 s40, s14, 2712576
    s_waitcnt vmcnt(12)
    buffer_store_dword v11, v12, s[20:23], 0 offen sc1
    v_max3_f32 v44, v96, v97, v98
    v_min3_f32 v45, v96, v97, v98
    v_max3_f32 v44, v44, v99, v100
    v_min3_f32 v45, v45, v99, v100
    buffer_load_dwordx4 a[68:71], v2, s[20:23], s40 offen offset:0 sc1
    v_max3_f32 v44, v44, v101, v102
    v_min3_f32 v45, v45, v101, v102
    v_max3_f32 v44, v44, v103, v104
    v_min3_f32 v45, v45, v103, v104
    v_max_f32 v44, v44, v105
    v_min_f32 v45, v45, v105
    v_mov_b32 v46, v44
    v_mov_b32 v47, v45
    s_nop 0
    v_permlane32_swap_b32 v44, v46
    v_permlane32_swap_b32 v45, v47
    v_max_f32 v44, v44, v46
    v_min_f32 v45, v45, v47
    v_mul_f32 v44, v6, v44
    v_mul_f32 v45, v6, v45
    v_fma_f32 v68, -v96, v6, v44
    v_fma_f32 v96, v96, v6, -v45
    buffer_load_dwordx4 a[72:75], v2, s[20:23], s40 offen offset:1024 sc1
    v_fma_f32 v69, -v97, v6, v44
    v_fma_f32 v97, v97, v6, -v45
    v_fma_f32 v70, -v98, v6, v44
    v_fma_f32 v98, v98, v6, -v45
    v_fma_f32 v71, -v99, v6, v44
    v_fma_f32 v99, v99, v6, -v45
    v_fma_f32 v72, -v100, v6, v44
    v_fma_f32 v100, v100, v6, -v45
    v_fma_f32 v73, -v101, v6, v44
    v_fma_f32 v101, v101, v6, -v45
    v_fma_f32 v74, -v102, v6, v44
    v_fma_f32 v102, v102, v6, -v45
    v_fma_f32 v75, -v103, v6, v44
    v_fma_f32 v103, v103, v6, -v45
    v_fma_f32 v76, -v104, v6, v44
    v_fma_f32 v104, v104, v6, -v45
    buffer_load_dwordx4 a[76:79], v2, s[20:23], s40 offen offset:2048 sc1
    v_fma_f32 v77, -v105, v6, v44
    v_fma_f32 v105, v105, v6, -v45
    v_exp_f32 v68, v68
    v_exp_f32 v96, v96
    v_exp_f32 v69, v69
    v_exp_f32 v97, v97
    v_exp_f32 v70, v70
    v_exp_f32 v98, v98
    v_exp_f32 v71, v71
    v_exp_f32 v99, v99
    buffer_load_dwordx4 a[80:83], v2, s[20:23], s40 offen offset:3072 sc1
    v_exp_f32 v72, v72
    v_exp_f32 v100, v100
    v_exp_f32 v73, v73
    v_exp_f32 v101, v101
    v_exp_f32 v74, v74
    v_exp_f32 v102, v102
    v_exp_f32 v75, v75
    v_exp_f32 v103, v103
    buffer_load_dwordx4 a[84:87], v26, s[20:23], s40 offen offset:0 sc1
    s_add_u32 s40, s14, 2717696
    v_exp_f32 v76, v76
    v_exp_f32 v104, v104
    v_exp_f32 v77, v77
    v_exp_f32 v105, v105
    v_add_f32 v46, v68, v69
    v_add_f32 v47, v96, v97
    v_add_f32 v46, v46, v70
    v_add_f32 v47, v47, v98
    v_add_f32 v46, v46, v71
    v_add_f32 v47, v47, v99
    v_add_f32 v46, v46, v72
    buffer_load_dwordx4 a[88:91], v2, s[20:23], s40 offen offset:0 sc1
    v_add_f32 v47, v47, v100
    v_add_f32 v46, v46, v73
    v_add_f32 v47, v47, v101
    v_add_f32 v46, v46, v74
    v_add_f32 v47, v47, v102
    v_add_f32 v46, v46, v75
    v_add_f32 v47, v47, v103
    v_add_f32 v46, v46, v76
    v_add_f32 v47, v47, v104
    v_add_f32 v46, v46, v77
    v_add_f32 v47, v47, v105
    v_mov_b32 v44, v46
    v_mov_b32 v45, v47
    s_nop 0
    v_permlane32_swap_b32 v46, v44
    v_permlane32_swap_b32 v47, v45
    buffer_load_dwordx4 a[92:95], v2, s[20:23], s40 offen offset:1024 sc1
    v_add_f32 v46, v46, v44
    v_add_f32 v47, v47, v45
    v_rcp_f32 v46, v46
    v_rcp_f32 v47, v47
    v_mul_f32 v68, v46, v68
    v_mul_f32 v96, v47, v96
    v_mul_f32 v69, v46, v69
    v_mul_f32 v97, v47, v97
    v_mul_f32 v70, v46, v70
    v_mul_f32 v98, v47, v98
    v_mul_f32 v71, v46, v71
    v_mul_f32 v99, v47, v99
    v_mul_f32 v72, v46, v72
    v_mul_f32 v100, v47, v100
    v_mul_f32 v73, v46, v73
    buffer_load_dwordx4 a[96:99], v2, s[20:23], s40 offen offset:2048 sc1
    v_mul_f32 v101, v47, v101
    v_mul_f32 v74, v46, v74
    v_mul_f32 v102, v47, v102
    v_mul_f32 v75, v46, v75
    v_mul_f32 v103, v47, v103
    v_mul_f32 v76, v46, v76
    v_mul_f32 v104, v47, v104
    v_mul_f32 v77, v46, v77
    v_mul_f32 v105, v47, v105
    v_cvt_pk_bf16_f32 v160, v68, v69
    v_cvt_pk_bf16_f32 v164, v96, v97
    v_cvt_pk_bf16_f32 v161, v70, v71
    v_cvt_pk_bf16_f32 v165, v98, v99
    v_cvt_pk_bf16_f32 v162, v72, v73
    v_cvt_pk_bf16_f32 v166, v100, v101
    v_cvt_pk_bf16_f32 v163, v74, v75
    buffer_load_dwordx4 a[100:103], v2, s[20:23], s40 offen offset:3072 sc1
    v_cvt_pk_bf16_f32 v167, v102, v103
    v_cvt_pk_bf16_f32 v168, v76, v77
    v_cvt_pk_bf16_f32 v169, v104, v105
    s_waitcnt vmcnt(21)
    v_cmp_ne_u32 vcc, s47, v28
    s_nop 4
    s_cbranch_vccnz Lpoll4
Lpoll4_ret:
    v_max3_f32 v44, v112, v113, v114
    v_min3_f32 v45, v112, v113, v114
    v_max3_f32 v44, v44, v115, v116
    v_min3_f32 v45, v45, v115, v116
    v_max3_f32 v44, v44, v117, v118
    v_min3_f32 v45, v45, v117, v118
    v_max3_f32 v44, v44, v119, v120
    v_min3_f32 v45, v45, v119, v120
    v_max_f32 v44, v44, v121
    v_min_f32 v45, v45, v121
    v_mov_b32 v46, v44
    v_mov_b32 v47, v45
    buffer_load_dwordx4 a[104:107], v26, s[20:23], s40 offen offset:0 sc1
    s_add_u32 s40, s14, 2722816
    s_nop 0
    v_permlane32_swap_b32 v44, v46
    v_permlane32_swap_b32 v45, v47
    v_max_f32 v44, v44, v46
    v_min_f32 v45, v45, v47
    v_mul_f32 v44, v6, v44
    v_mul_f32 v45, v6, v45
    v_fma_f32 v68, -v112, v6, v44
    v_fma_f32 v112, v112, v6, -v45
    v_fma_f32 v69, -v113, v6, v44
    v_fma_f32 v113, v113, v6, -v45
    v_fma_f32 v70, -v114, v6, v44
    v_fma_f32 v114, v114, v6, -v45
    v_fma_f32 v71, -v115, v6, v44
    v_fma_f32 v115, v115, v6, -v45
    buffer_load_dwordx4 a[108:111], v2, s[20:23], s40 offen offset:0 sc1
    v_fma_f32 v72, -v116, v6, v44
    v_fma_f32 v116, v116, v6, -v45
    v_fma_f32 v73, -v117, v6, v44
    v_fma_f32 v117, v117, v6, -v45
    v_fma_f32 v74, -v118, v6, v44
    v_fma_f32 v118, v118, v6, -v45
    v_fma_f32 v75, -v119, v6, v44
    v_fma_f32 v119, v119, v6, -v45
    v_fma_f32 v76, -v120, v6, v44
    v_fma_f32 v120, v120, v6, -v45
    v_fma_f32 v77, -v121, v6, v44
    v_fma_f32 v121, v121, v6, -v45
    v_exp_f32 v68, v68
    v_exp_f32 v112, v112
    v_exp_f32 v69, v69
    buffer_load_dwordx4 a[112:115], v2, s[20:23], s40 offen offset:1024 sc1
    v_exp_f32 v113, v113
    v_exp_f32 v70, v70
    v_exp_f32 v114, v114
    v_exp_f32 v71, v71
    v_exp_f32 v115, v115
    v_exp_f32 v72, v72
    v_exp_f32 v116, v116
    v_exp_f32 v73, v73
    buffer_load_dwordx4 a[116:119], v2, s[20:23], s40 offen offset:2048 sc1
    v_exp_f32 v117, v117
    v_exp_f32 v74, v74
    v_exp_f32 v118, v118
    v_exp_f32 v75, v75
    v_exp_f32 v119, v119
    v_exp_f32 v76, v76
    v_exp_f32 v120, v120
    v_exp_f32 v77, v77
    buffer_load_dwordx4 v[208:211], v2, s[20:23], s40 offen offset:3072 sc1
    v_exp_f32 v121, v121
    v_add_f32 v46, v68, v69
    v_add_f32 v47, v112, v113
    v_add_f32 v46, v46, v70
    v_add_f32 v47, v47, v114
    v_add_f32 v46, v46, v71
    v_add_f32 v47, v47, v115
    v_add_f32 v46, v46, v72
    v_add_f32 v47, v47, v116
    v_add_f32 v46, v46, v73
    v_add_f32 v47, v47, v117
    v_add_f32 v46, v46, v74
    v_add_f32 v47, v47, v118
    v_add_f32 v46, v46, v75
    v_add_f32 v47, v47, v119
    buffer_load_dwordx4 v[212:215], v26, s[20:23], s40 offen offset:0 sc1
    s_add_u32 s40, s16, 5472256
    v_add_f32 v46, v46, v76
    v_add_f32 v47, v47, v120
    v_add_f32 v46, v46, v77
    v_add_f32 v47, v47, v121
    v_mov_b32 v44, v46
    v_mov_b32 v45, v47
    s_nop 0
    v_permlane32_swap_b32 v46, v44
    v_permlane32_swap_b32 v47, v45
    v_add_f32 v46, v46, v44
    v_add_f32 v47, v47, v45
    v_rcp_f32 v46, v46
    v_rcp_f32 v47, v47
    v_mul_f32 v68, v46, v68
    buffer_load_dwordx4 v[216:219], v32, s[20:23], s40 offen sc1
    v_mul_f32 v112, v47, v112
    v_mul_f32 v69, v46, v69
    v_mul_f32 v113, v47, v113
    v_mul_f32 v70, v46, v70
    v_mul_f32 v114, v47, v114
    v_mul_f32 v71, v46, v71
    v_mul_f32 v115, v47, v115
    v_mul_f32 v72, v46, v72
    v_mul_f32 v116, v47, v116
    v_mul_f32 v73, v46, v73
    v_mul_f32 v117, v47, v117
    v_mul_f32 v74, v46, v74
    v_mul_f32 v118, v47, v118
    v_mul_f32 v75, v46, v75
    v_mul_f32 v119, v47, v119
    v_mul_f32 v76, v46, v76
    buffer_load_dwordx4 v[220:223], v33, s[20:23], s40 offen sc1
    v_mul_f32 v120, v47, v120
    v_mul_f32 v77, v46, v77
    v_mul_f32 v121, v47, v121
    v_cvt_pk_bf16_f32 v172, v68, v69
    v_cvt_pk_bf16_f32 v176, v112, v113
    v_cvt_pk_bf16_f32 v173, v70, v71
    v_cvt_pk_bf16_f32 v177, v114, v115
    v_cvt_pk_bf16_f32 v174, v72, v73
    v_cvt_pk_bf16_f32 v178, v116, v117
    v_cvt_pk_bf16_f32 v175, v74, v75
    v_cvt_pk_bf16_f32 v179, v118, v119
    v_cvt_pk_bf16_f32 v180, v76, v77
    v_cvt_pk_bf16_f32 v181, v120, v121
    v_mov_b32 v170, 0
    v_mov_b32 v171, 0
    v_mov_b32 v182, 0
    v_mov_b32 v183, 0
    buffer_load_dwordx4 v[224:227], v34, s[20:23], s40 offen sc1
    s_lshl_b32 s46, s19, 4
    s_lshl3_add_u32 s46, s45, s46
    s_mul_i32 s46, s46, 1792
    s_add_u32 s46, s46, 14385152
    v_and_b32 v8, 1, v20
    v_lshlrev_b32 v8, 4, v8
    v_mov_b32 v9, 0x3f80
    v_lshlrev_b32 v8, v8, v9
    v_cmp_eq_u32 vcc, v14, v15
    s_nop 1
    v_cndmask_b32 v8, 0, v8, vcc
    v_cmp_gt_u32 vcc, 2, v20
    s_nop 1
    v_cndmask_b32 v36, 0, v8, vcc
    v_cndmask_b32 v37, v8, 0, vcc
    v_cndmask_b32 v40, 0, v8, vcc
    v_cndmask_b32 v41, v8, 0, vcc
    v_cndmask_b32 v42, 0, v8, vcc
    buffer_load_dwordx4 v[228:231], v35, s[20:23], s40 offen sc1
    s_add_u32 s40, s16, 5476352
    v_cndmask_b32 v43, v8, 0, vcc
    v_mov_b32 v38, 0
    v_mov_b32 v39, 0
    s_mul_i32 s55, s50, 5
    v_add_u32 v8, s55, v21
    v_lshrrev_b32 v9, 2, v8
    v_and_b32 v8, 3, v8
    v_lshl_add_u32 v9, v9, 12, v24
    v_lshl_add_u32 v4, v8, 8, v9
    v_add_u32 v8, s55, v21
    v_add_u32 v8, 2, v8
    v_lshrrev_b32 v9, 2, v8
    v_and_b32 v8, 3, v8
    v_lshl_add_u32 v9, v9, 12, v24
    v_lshl_add_u32 v5, v8, 8, v9
    v_add_u32 v8, s55, v21
    buffer_load_dwordx4 v[232:235], v32, s[20:23], s40 offen sc1
    v_add_u32 v8, 4, v8
    v_lshrrev_b32 v9, 2, v8
    v_and_b32 v8, 3, v8
    v_lshl_add_u32 v9, v9, 12, v24
    v_lshl_add_u32 v6, v8, 8, v9
    v_lshl_add_u32 v6, v21, 31, v6
    buffer_load_dword v16, v13, s[20:23], 0 offen sc1
    buffer_load_dwordx4 v[236:239], v33, s[20:23], s40 offen sc1
    buffer_load_dwordx4 v[240:243], v34, s[20:23], s40 offen sc1
    buffer_load_dwordx4 v[244:247], v35, s[20:23], s40 offen sc1
    s_add_u32 s40, s16, 5480448
    buffer_load_dwordx4 v[248:251], v32, s[20:23], s40 offen sc1
    buffer_load_dwordx4 v[252:255], v33, s[20:23], s40 offen sc1
    buffer_load_dwordx4 a[120:123], v34, s[20:23], s40 offen sc1
    buffer_load_dwordx4 a[124:127], v35, s[20:23], s40 offen sc1
    s_add_u32 s40, s16, 5484544
    s_waitcnt vmcnt(12)
    v_mfma_f32_16x16x32_bf16 a[0:3], a[160:163], v[216:219], 0
    buffer_load_dwordx4 a[128:131], v32, s[20:23], s40 offen sc1
    v_mfma_f32_16x16x32_bf16 a[4:7], a[164:167], v[216:219], 0
    v_mfma_f32_16x16x32_bf16 a[8:11], a[168:171], v[216:219], 0
    v_mfma_f32_16x16x32_bf16 a[12:15], a[172:175], v[216:219], 0
    v_mfma_f32_16x16x32_bf16 a[16:19], a[176:179], v[216:219], 0
    s_waitcnt vmcnt(12)
    v_mfma_f32_16x16x32_bf16 a[20:23], a[160:163], v[220:223], 0
    buffer_load_dwordx4 a[132:135], v33, s[20:23], s40 offen sc1
    v_mfma_f32_16x16x32_bf16 a[24:27], a[164:167], v[220:223], 0
    v_mfma_f32_16x16x32_bf16 a[28:31], a[168:171], v[220:223], 0
    v_mfma_f32_16x16x32_bf16 a[32:35], a[172:175], v[220:223], 0
    v_mfma_f32_16x16x32_bf16 a[36:39], a[176:179], v[220:223], 0
    buffer_load_dwordx4 a[136:139], v34, s[20:23], s40 offen sc1
    s_waitcnt vmcnt(13)
    v_mfma_f32_16x16x32_bf16 a[40:43], a[160:163], v[224:227], 0
    v_mfma_f32_16x16x32_bf16 a[44:47], a[164:167], v[224:227], 0
    v_mfma_f32_16x16x32_bf16 a[48:51], a[168:171], v[224:227], 0
    v_mfma_f32_16x16x32_bf16 a[52:55], a[172:175], v[224:227], 0
    buffer_load_dwordx4 a[140:143], v35, s[20:23], s40 offen sc1
    v_mfma_f32_16x16x32_bf16 a[56:59], a[176:179], v[224:227], 0
    s_waitcnt vmcnt(13)
    v_mfma_f32_16x16x32_bf16 v[184:187], a[160:163], v[228:231], 0
    v_mfma_f32_16x16x32_bf16 v[188:191], a[164:167], v[228:231], 0
    v_mfma_f32_16x16x32_bf16 v[192:195], a[168:171], v[228:231], 0
    v_mfma_f32_16x16x32_bf16 v[196:199], a[172:175], v[228:231], 0
    s_waitcnt vmcnt(11)
    v_cmp_ne_u32 vcc, s47, v16
    s_nop 4
    s_cbranch_vccnz Lpoll5
Lpoll5_ret:
    v_mfma_f32_16x16x32_bf16 v[200:203], a[176:179], v[228:231], 0
    buffer_load_dwordx4 v[80:83], v29, s[20:23], s46 offen sc1
    buffer_load_dwordx4 v[84:87], v29, s[20:23], s46 offen offset:704 sc1
    v_mfma_f32_16x16x32_bf16 a[0:3], a[180:183], v[232:235], a[0:3]
    buffer_load_dwordx2 v[144:145], v30, s[20:23], s46 offen offset:1408 sc1
    s_add_u32 s46, s46, 1792
    v_mfma_f32_16x16x32_bf16 a[4:7], a[184:187], v[232:235], a[4:7]
    buffer_load_dwordx4 v[88:91], v29, s[20:23], s46 offen sc1
    buffer_load_dwordx4 v[92:95], v29, s[20:23], s46 offen offset:704 sc1
    v_mfma_f32_16x16x32_bf16 a[8:11], a[188:191], v[232:235], a[8:11]
    v_mfma_f32_16x16x32_bf16 a[12:15], a[192:195], v[232:235], a[12:15]
    v_mfma_f32_16x16x32_bf16 a[16:19], a[196:199], v[232:235], a[16:19]
    s_waitcnt vmcnt(15)
    v_mfma_f32_16x16x32_bf16 a[20:23], a[180:183], v[236:239], a[20:23]
    buffer_load_dwordx2 v[146:147], v30, s[20:23], s46 offen offset:1408 sc1
    s_add_u32 s46, s46, 1792
    v_mfma_f32_16x16x32_bf16 a[24:27], a[184:187], v[236:239], a[24:27]
    v_mfma_f32_16x16x32_bf16 a[28:31], a[188:191], v[236:239], a[28:31]
    buffer_load_dwordx4 v[96:99], v29, s[20:23], s46 offen sc1
    v_mfma_f32_16x16x32_bf16 a[32:35], a[192:195], v[236:239], a[32:35]
    v_mfma_f32_16x16x32_bf16 a[36:39], a[196:199], v[236:239], a[36:39]
    s_waitcnt vmcnt(16)
    v_mfma_f32_16x16x32_bf16 a[40:43], a[180:183], v[240:243], a[40:43]
    buffer_load_dwordx4 v[100:103], v29, s[20:23], s46 offen offset:704 sc1
    v_mfma_f32_16x16x32_bf16 a[44:47], a[184:187], v[240:243], a[44:47]
    v_mfma_f32_16x16x32_bf16 a[48:51], a[188:191], v[240:243], a[48:51]
    v_mfma_f32_16x16x32_bf16 a[52:55], a[192:195], v[240:243], a[52:55]
    buffer_load_dwordx2 v[148:149], v30, s[20:23], s46 offen offset:1408 sc1
    v_mfma_f32_16x16x32_bf16 a[56:59], a[196:199], v[240:243], a[56:59]
    s_add_u32 s46, s46, 1792
    s_waitcnt vmcnt(17)
    v_mfma_f32_16x16x32_bf16 v[184:187], a[180:183], v[244:247], v[184:187]
    buffer_load_dwordx4 v[104:107], v29, s[20:23], s46 offen sc1
    v_mfma_f32_16x16x32_bf16 v[188:191], a[184:187], v[244:247], v[188:191]
    v_mfma_f32_16x16x32_bf16 v[192:195], a[188:191], v[244:247], v[192:195]
    v_mfma_f32_16x16x32_bf16 v[196:199], a[192:195], v[244:247], v[196:199]
    v_mfma_f32_16x16x32_bf16 v[200:203], a[196:199], v[244:247], v[200:203]
    buffer_load_dwordx4 v[108:111], v29, s[20:23], s46 offen offset:704 sc1
    s_waitcnt vmcnt(18)
    v_mfma_f32_16x16x32_bf16 a[0:3], a[200:203], v[248:251], a[0:3]
    v_mfma_f32_16x16x32_bf16 a[4:7], a[204:207], v[248:251], a[4:7]
    v_mfma_f32_16x16x32_bf16 a[8:11], a[208:211], v[248:251], a[8:11]
    buffer_load_dwordx2 v[150:151], v30, s[20:23], s46 offen offset:1408 sc1
    s_add_u32 s46, s46, 1792
    v_mfma_f32_16x16x32_bf16 a[12:15], a[212:215], v[248:251], a[12:15]
    v_mfma_f32_16x16x32_bf16 a[16:19], a[216:219], v[248:251], a[16:19]
    buffer_load_dwordx4 v[112:115], v29, s[20:23], s46 offen sc1
    s_waitcnt vmcnt(19)
    v_mfma_f32_16x16x32_bf16 a[20:23], a[200:203], v[252:255], a[20:23]
    v_mfma_f32_16x16x32_bf16 a[24:27], a[204:207], v[252:255], a[24:27]
    v_mfma_f32_16x16x32_bf16 a[28:31], a[208:211], v[252:255], a[28:31]
    v_mfma_f32_16x16x32_bf16 a[32:35], a[212:215], v[252:255], a[32:35]
    buffer_load_dwordx4 v[116:119], v29, s[20:23], s46 offen offset:704 sc1
    v_mfma_f32_16x16x32_bf16 a[36:39], a[216:219], v[252:255], a[36:39]
    s_waitcnt vmcnt(19)
    v_mfma_f32_16x16x32_bf16 a[40:43], a[200:203], a[120:123], a[40:43]
    v_mfma_f32_16x16x32_bf16 a[44:47], a[204:207], a[120:123], a[44:47]
    buffer_load_dwordx2 v[152:153], v30, s[20:23], s46 offen offset:1408 sc1
    s_add_u32 s46, s46, 1792
    v_mfma_f32_16x16x32_bf16 a[48:51], a[208:211], a[120:123], a[48:51]
    v_mfma_f32_16x16x32_bf16 a[52:55], a[212:215], a[120:123], a[52:55]
    buffer_load_dwordx4 v[120:123], v29, s[20:23], s46 offen sc1
    v_mfma_f32_16x16x32_bf16 a[56:59], a[216:219], a[120:123], a[56:59]
    s_waitcnt vmcnt(20)
    v_mfma_f32_16x16x32_bf16 v[184:187], a[200:203], a[124:127], v[184:187]
    v_mfma_f32_16x16x32_bf16 v[188:191], a[204:207], a[124:127], v[188:191]
    buffer_load_dwordx4 v[124:127], v29, s[20:23], s46 offen offset:704 sc1
    v_mfma_f32_16x16x32_bf16 v[192:195], a[208:211], a[124:127], v[192:195]
    v_mfma_f32_16x16x32_bf16 v[196:199], a[212:215], a[124:127], v[196:199]
    v_mfma_f32_16x16x32_bf16 v[200:203], a[216:219], a[124:127], v[200:203]
    s_waitcnt vmcnt(20)
    v_mfma_f32_16x16x32_bf16 a[0:3], a[220:223], a[128:131], a[0:3]
    buffer_load_dwordx2 v[154:155], v30, s[20:23], s46 offen offset:1408 sc1
    s_add_u32 s46, s46, 1792
    v_mfma_f32_16x16x32_bf16 a[4:7], a[224:227], a[128:131], a[4:7]
    v_mfma_f32_16x16x32_bf16 a[8:11], a[228:231], a[128:131], a[8:11]
    buffer_load_dwordx4 v[128:131], v29, s[20:23], s46 offen sc1
    v_mfma_f32_16x16x32_bf16 a[12:15], a[232:235], a[128:131], a[12:15]
    v_mfma_f32_16x16x32_bf16 a[16:19], a[236:239], a[128:131], a[16:19]
    s_waitcnt vmcnt(21)
    v_mfma_f32_16x16x32_bf16 a[20:23], a[220:223], a[132:135], a[20:23]
    buffer_load_dwordx4 v[132:135], v29, s[20:23], s46 offen offset:704 sc1
    v_mfma_f32_16x16x32_bf16 a[24:27], a[224:227], a[132:135], a[24:27]
    v_mfma_f32_16x16x32_bf16 a[28:31], a[228:231], a[132:135], a[28:31]
    v_mfma_f32_16x16x32_bf16 a[32:35], a[232:235], a[132:135], a[32:35]
    buffer_load_dwordx2 v[156:157], v30, s[20:23], s46 offen offset:1408 sc1
    v_mfma_f32_16x16x32_bf16 a[36:39], a[236:239], a[132:135], a[36:39]
    s_add_u32 s46, s46, 1792
    s_waitcnt vmcnt(22)
    v_mfma_f32_16x16x32_bf16 a[40:43], a[220:223], a[136:139], a[40:43]
    buffer_load_dwordx4 v[136:139], v29, s[20:23], s46 offen sc1
    v_mfma_f32_16x16x32_bf16 a[44:47], a[224:227], a[136:139], a[44:47]
    v_mfma_f32_16x16x32_bf16 a[48:51], a[228:231], a[136:139], a[48:51]
    v_mfma_f32_16x16x32_bf16 a[52:55], a[232:235], a[136:139], a[52:55]
    v_mfma_f32_16x16x32_bf16 a[56:59], a[236:239], a[136:139], a[56:59]
    buffer_load_dwordx4 v[140:143], v29, s[20:23], s46 offen offset:704 sc1
    s_waitcnt vmcnt(23)
    v_mfma_f32_16x16x32_bf16 v[184:187], a[220:223], a[140:143], v[184:187]
    v_mfma_f32_16x16x32_bf16 v[188:191], a[224:227], a[140:143], v[188:191]
    v_mfma_f32_16x16x32_bf16 v[192:195], a[228:231], a[140:143], v[192:195]
    buffer_load_dwordx2 v[158:159], v30, s[20:23], s46 offen offset:1408 sc1
    s_mul_i32 s46, s44, 5120
    v_mfma_f32_16x16x32_bf16 v[196:199], a[232:235], a[140:143], v[196:199]
    s_add_u32 s40, s14, 2727936
    s_add_u32 s46, s46, 83968
    v_mfma_f32_16x16x32_bf16 v[200:203], a[236:239], a[140:143], v[200:203]
    v_add_u32 v8, s46, v2
    v_add_u32 v9, 83968, v2
    s_add_u32 s55, s11, 196608
    s_add_u32 s46, s12, 15729664
    v_lshlrev_b32 v12, 24, v1
    v_add_u32 v12, s46, v12
    v_and_b32 v10, 7, v1
    v_add_lshl_u32 v10, s13, v10, 7
    v_add_u32 v13, 15729664, v10
    s_waitcnt vmcnt(23)
    v_mfma_f32_16x16x32_bf16 v[60:63], v[36:39], v[80:83], 0
    v_mfma_f32_16x16x32_bf16 v[64:67], v[38:41], v[80:83], 0
    s_waitcnt vmcnt(22)
    v_mfma_f32_16x16x32_bf16 v[68:71], v[36:39], v[84:87], 0
    v_mfma_f32_16x16x32_bf16 v[72:75], v[38:41], v[84:87], 0
    s_waitcnt vmcnt(20)
    v_mfma_f32_16x16x32_bf16 v[60:63], v[36:39], v[88:91], v[60:63]
    v_mfma_f32_16x16x32_bf16 v[64:67], v[38:41], v[88:91], v[64:67]
    s_waitcnt vmcnt(19)
    v_mfma_f32_16x16x32_bf16 v[68:71], v[36:39], v[92:95], v[68:71]
    buffer_load_dwordx4 a[144:147], v2, s[20:23], s40 offen offset:0 sc1
    v_mfma_f32_16x16x32_bf16 v[72:75], v[38:41], v[92:95], v[72:75]
    s_waitcnt vmcnt(19)
    v_mfma_f32_16x16x32_bf16 v[76:79], v[40:43], v[144:147], 0
    s_waitcnt vmcnt(18)
    v_mfma_f32_16x16x32_bf16 v[60:63], v[36:39], v[96:99], v[60:63]
    v_mfma_f32_16x16x32_bf16 v[64:67], v[38:41], v[96:99], v[64:67]
    buffer_load_dwordx4 a[148:151], v2, s[20:23], s40 offen offset:1024 sc1
    s_waitcnt vmcnt(18)
    v_mfma_f32_16x16x32_bf16 v[68:71], v[36:39], v[100:103], v[68:71]
    v_mfma_f32_16x16x32_bf16 v[72:75], v[38:41], v[100:103], v[72:75]
    s_waitcnt vmcnt(16)
    v_mfma_f32_16x16x32_bf16 v[60:63], v[36:39], v[104:107], v[60:63]
    v_mfma_f32_16x16x32_bf16 v[64:67], v[38:41], v[104:107], v[64:67]
    buffer_load_dwordx4 a[152:155], v2, s[20:23], s40 offen offset:2048 sc1
    s_waitcnt vmcnt(16)
    v_mfma_f32_16x16x32_bf16 v[68:71], v[36:39], v[108:111], v[68:71]
    v_mfma_f32_16x16x32_bf16 v[72:75], v[38:41], v[108:111], v[72:75]
    s_waitcnt vmcnt(15)
    v_mfma_f32_16x16x32_bf16 v[76:79], v[40:43], v[148:151], v[76:79]
    buffer_load_dwordx4 a[156:159], v2, s[20:23], s40 offen offset:3072 sc1
    s_waitcnt vmcnt(15)
    v_mfma_f32_16x16x32_bf16 v[60:63], v[36:39], v[112:115], v[60:63]
    v_mfma_f32_16x16x32_bf16 v[64:67], v[38:41], v[112:115], v[64:67]
    buffer_load_dwordx4 v[216:219], v26, s[20:23], s40 offen offset:0 sc1
    s_add_u32 s40, s16, 5488640
    s_waitcnt vmcnt(15)
    v_mfma_f32_16x16x32_bf16 v[68:71], v[36:39], v[116:119], v[68:71]
    v_mfma_f32_16x16x32_bf16 v[72:75], v[38:41], v[116:119], v[72:75]
    buffer_load_dwordx4 v[220:223], v32, s[20:23], s40 offen sc1
    s_waitcnt vmcnt(14)
    v_mfma_f32_16x16x32_bf16 v[60:63], v[36:39], v[120:123], v[60:63]
    v_mfma_f32_16x16x32_bf16 v[64:67], v[38:41], v[120:123], v[64:67]
    buffer_load_dwordx4 v[224:227], v33, s[20:23], s40 offen sc1
    s_waitcnt vmcnt(14)
    v_mfma_f32_16x16x32_bf16 v[68:71], v[36:39], v[124:127], v[68:71]
    v_mfma_f32_16x16x32_bf16 v[72:75], v[38:41], v[124:127], v[72:75]
    s_waitcnt vmcnt(13)
    v_mfma_f32_16x16x32_bf16 v[76:79], v[40:43], v[152:155], v[76:79]
    buffer_load_dwordx4 a[160:163], v34, s[20:23], s40 offen sc1
    s_waitcnt vmcnt(13)
    v_mfma_f32_16x16x32_bf16 v[60:63], v[36:39], v[128:131], v[60:63]
    v_mfma_f32_16x16x32_bf16 v[64:67], v[38:41], v[128:131], v[64:67]
    buffer_load_dwordx4 a[164:167], v35, s[20:23], s40 offen sc1
    s_add_u32 s40, s14, 2733056
    s_waitcnt vmcnt(13)
    v_mfma_f32_16x16x32_bf16 v[68:71], v[36:39], v[132:135], v[68:71]
    v_mfma_f32_16x16x32_bf16 v[72:75], v[38:41], v[132:135], v[72:75]
    buffer_load_dwordx4 a[168:171], v2, s[20:23], s40 offen offset:0 sc1
    s_waitcnt vmcnt(12)
    v_mfma_f32_16x16x32_bf16 v[60:63], v[36:39], v[136:139], v[60:63]
    v_mfma_f32_16x16x32_bf16 v[64:67], v[38:41], v[136:139], v[64:67]
    buffer_load_dwordx4 a[172:175], v2, s[20:23], s40 offen offset:1024 sc1
    s_waitcnt vmcnt(12)
    v_mfma_f32_16x16x32_bf16 v[68:71], v[36:39], v[140:143], v[68:71]
    v_mfma_f32_16x16x32_bf16 v[72:75], v[38:41], v[140:143], v[72:75]
    s_waitcnt vmcnt(11)
    v_mfma_f32_16x16x32_bf16 v[76:79], v[40:43], v[156:159], v[76:79]
    buffer_load_dwordx4 a[176:179], v2, s[20:23], s40 offen offset:2048 sc1
    ds_write_b128 v8, v[60:63] offset:0
    ds_write_b128 v8, v[64:67] offset:1024
    s_nop 1
    ds_write_b128 v8, v[68:71] offset:2048
    ds_write_b128 v8, v[72:75] offset:3072
    s_nop 0
    ds_write_b128 v8, v[76:79] offset:4096
    s_waitcnt lgkmcnt(0)
    s_barrier
    ds_read_b128 v[80:83], v9 offset:0
    ds_read_b128 v[84:87], v9 offset:1024
    ds_read_b128 v[88:91], v9 offset:2048
    ds_read_b128 v[92:95], v9 offset:3072
    ds_read_b128 v[96:99], v9 offset:4096
    ds_read_b128 v[100:103], v9 offset:5120
    ds_read_b128 v[104:107], v9 offset:6144
    buffer_load_dwordx4 v[228:231], v2, s[20:23], s40 offen offset:3072 sc1
    ds_read_b128 v[108:111], v9 offset:7168
    ds_read_b128 v[112:115], v9 offset:8192
    ds_read_b128 v[116:119], v9 offset:9216
    ds_read_b128 v[120:123], v9 offset:10240
    ds_read_b128 v[124:127], v9 offset:11264
    ds_read_b128 v[128:131], v9 offset:12288
    ds_read_b128 v[132:135], v9 offset:13312
    ds_read_b128 v[136:139], v9 offset:14336
    ds_read_b128 v[140:143], v9 offset:15360
    ds_read_b128 v[144:147], v9 offset:16384
    ds_read_b128 v[148:151], v9 offset:17408
    ds_read_b128 v[152:155], v9 offset:18432
    ds_read_b128 v[156:159], v9 offset:19456
    buffer_load_dwordx4 v[232:235], v26, s[20:23], s40 offen offset:0 sc1
    s_add_u32 s40, s16, 5492736
    s_waitcnt lgkmcnt(14)
    v_add_f32 v80, v80, v100
    v_add_f32 v81, v81, v101
    v_add_f32 v82, v82, v102
    v_add_f32 v83, v83, v103
    s_waitcnt lgkmcnt(13)
    v_add_f32 v84, v84, v104
    v_add_f32 v85, v85, v105
    v_add_f32 v86, v86, v106
    v_add_f32 v87, v87, v107
    s_waitcnt lgkmcnt(12)
    v_add_f32 v88, v88, v108
    v_add_f32 v89, v89, v109
    buffer_load_dwordx4 v[236:239], v32, s[20:23], s40 offen sc1
    v_add_f32 v90, v90, v110
    v_add_f32 v91, v91, v111
    s_waitcnt lgkmcnt(11)
    v_add_f32 v92, v92, v112
    v_add_f32 v93, v93, v113
    v_add_f32 v94, v94, v114
    v_add_f32 v95, v95, v115
    s_waitcnt lgkmcnt(10)
    v_add_f32 v96, v96, v116
    v_add_f32 v97, v97, v117
    v_add_f32 v98, v98, v118
    v_add_f32 v99, v99, v119
    v_cvt_pk_bf16_f32 v100, v80, v81
    v_cvt_pk_bf16_f32 v101, v82, v83
    v_cvt_pk_bf16_f32 v102, v84, v85
    v_cvt_pk_bf16_f32 v103, v86, v87
    v_cvt_pk_bf16_f32 v104, v88, v89
    v_cvt_pk_bf16_f32 v105, v90, v91
    buffer_load_dwordx4 v[240:243], v33, s[20:23], s40 offen sc1
    v_cvt_pk_bf16_f32 v106, v92, v93
    v_cvt_pk_bf16_f32 v107, v94, v95
    v_cvt_pk_bf16_f32 v108, v96, v97
    v_cvt_pk_bf16_f32 v109, v98, v99
    v_mov_b32 v110, 0
    v_mov_b32 v111, 0
    v_mfma_f32_32x32x16_bf16 v[80:95], v[100:103], v[160:163], 0
    v_mfma_f32_32x32x16_bf16 v[80:95], v[104:107], v[164:167], v[80:95]
    buffer_load_dwordx4 a[180:183], v34, s[20:23], s40 offen sc1
    v_mfma_f32_32x32x16_bf16 v[80:95], v[108:111], v[168:171], v[80:95]
    s_waitcnt lgkmcnt(4)
    v_add_f32 v120, v120, v140
    v_add_f32 v121, v121, v141
    v_add_f32 v122, v122, v142
    v_add_f32 v123, v123, v143
    s_waitcnt lgkmcnt(3)
    v_add_f32 v124, v124, v144
    v_add_f32 v125, v125, v145
    v_add_f32 v126, v126, v146
    v_add_f32 v127, v127, v147
    s_waitcnt lgkmcnt(2)
    v_add_f32 v128, v128, v148
    v_add_f32 v129, v129, v149
    s_waitcnt vmcnt(11)
    v_mfma_f32_16x16x32_bf16 a[0:3], a[240:243], v[220:223], a[0:3]
    buffer_load_dwordx4 a[184:187], v35, s[20:23], s40 offen sc1
    s_add_u32 s40, s14, 2738176
    v_mfma_f32_16x16x32_bf16 a[4:7], a[244:247], v[220:223], a[4:7]
    v_add_f32 v130, v130, v150
    v_add_f32 v131, v131, v151
    v_mfma_f32_16x16x32_bf16 a[8:11], a[248:251], v[220:223], a[8:11]
    s_waitcnt lgkmcnt(1)
    v_add_f32 v132, v132, v152
    v_add_f32 v133, v133, v153
    v_mfma_f32_16x16x32_bf16 a[12:15], a[252:255], v[220:223], a[12:15]
    v_add_f32 v134, v134, v154
    v_add_f32 v135, v135, v155
    v_mfma_f32_16x16x32_bf16 a[16:19], a[64:67], v[220:223], a[16:19]
    buffer_load_dwordx4 a[188:191], v2, s[20:23], s40 offen offset:0 sc1
    s_waitcnt lgkmcnt(0)
    v_add_f32 v136, v136, v156
    s_waitcnt vmcnt(12)
    v_mfma_f32_16x16x32_bf16 a[20:23], a[240:243], v[224:227], a[20:23]
    v_add_f32 v137, v137, v157
    v_add_f32 v138, v138, v158
    v_mfma_f32_16x16x32_bf16 a[24:27], a[244:247], v[224:227], a[24:27]
    v_add_f32 v139, v139, v159
    v_cvt_pk_bf16_f32 v140, v120, v121
    v_mfma_f32_16x16x32_bf16 a[28:31], a[248:251], v[224:227], a[28:31]
    v_cvt_pk_bf16_f32 v141, v122, v123
    v_cvt_pk_bf16_f32 v142, v124, v125
    v_mfma_f32_16x16x32_bf16 a[32:35], a[252:255], v[224:227], a[32:35]
    v_cvt_pk_bf16_f32 v143, v126, v127
    buffer_load_dwordx4 a[192:195], v2, s[20:23], s40 offen offset:1024 sc1
    v_mfma_f32_16x16x32_bf16 a[36:39], a[64:67], v[224:227], a[36:39]
    v_cvt_pk_bf16_f32 v144, v128, v129
    v_cvt_pk_bf16_f32 v145, v130, v131
    s_waitcnt vmcnt(12)
    v_mfma_f32_16x16x32_bf16 a[40:43], a[240:243], a[160:163], a[40:43]
    v_cvt_pk_bf16_f32 v146, v132, v133
    v_cvt_pk_bf16_f32 v147, v134, v135
    v_mfma_f32_16x16x32_bf16 a[44:47], a[244:247], a[160:163], a[44:47]
    v_cvt_pk_bf16_f32 v148, v136, v137
    v_cvt_pk_bf16_f32 v149, v138, v139
    v_mfma_f32_16x16x32_bf16 a[48:51], a[248:251], a[160:163], a[48:51]
    v_mov_b32 v150, 0
    v_mov_b32 v151, 0
    v_mfma_f32_32x32x16_bf16 v[120:135], v[140:143], v[172:175], 0
    buffer_load_dwordx4 a[196:199], v2, s[20:23], s40 offen offset:2048 sc1
    v_mfma_f32_32x32x16_bf16 v[120:135], v[144:147], v[176:179], v[120:135]
    v_mfma_f32_32x32x16_bf16 v[120:135], v[148:151], v[180:183], v[120:135]
    buffer_load_dwordx4 v[244:247], v2, s[20:23], s40 offen offset:3072 sc1
    v_cmp_eq_u32 vcc, 0, v21
    s_nop 1
    v_cndmask_b32 v36, v88, v92, vcc
    v_add_f32 v36, 0x358637bd, v36
    v_rcp_f32 v36, v36
    v_mfma_f32_16x16x32_bf16 a[52:55], a[252:255], a[160:163], a[52:55]
    v_mul_f32 v80, v80, v36
    v_mul_f32 v81, v81, v36
    v_mfma_f32_16x16x32_bf16 a[56:59], a[64:67], a[160:163], a[56:59]
    v_mul_f32 v82, v82, v36
    v_mul_f32 v83, v83, v36
    s_waitcnt vmcnt(13)
    v_mfma_f32_16x16x32_bf16 v[184:187], a[240:243], a[164:167], v[184:187]
    v_mul_f32 v84, v84, v36
    v_mul_f32 v85, v85, v36
    v_mfma_f32_16x16x32_bf16 v[188:191], a[244:247], a[164:167], v[188:191]
    buffer_load_dwordx4 v[248:251], v26, s[20:23], s40 offen offset:0 sc1
    s_add_u32 s40, s16, 5496832
    v_mfma_f32_16x16x32_bf16 v[192:195], a[248:251], a[164:167], v[192:195]
    v_mul_f32 v86, v86, v36
    v_mul_f32 v87, v87, v36
    v_mfma_f32_16x16x32_bf16 v[196:199], a[252:255], a[164:167], v[196:199]
    v_mul_f32 v88, v88, v36
    v_mul_f32 v89, v89, v36
    v_mfma_f32_16x16x32_bf16 v[200:203], a[64:67], a[164:167], v[200:203]
    v_mul_f32 v90, v90, v36
    v_mul_f32 v91, v91, v36
    v_cvt_pk_bf16_f32 v60, v80, v81
    buffer_load_dwordx4 v[252:255], v32, s[20:23], s40 offen sc1
    v_cvt_pk_bf16_f32 v61, v82, v83
    v_cvt_pk_bf16_f32 v62, v84, v85
    v_cvt_pk_bf16_f32 v63, v86, v87
    v_cvt_pk_bf16_f32 v68, v88, v89
    v_cvt_pk_bf16_f32 v69, v90, v91
    buffer_store_dwordx4 v[60:63], v4, s[20:23], s55 offen sc1
    v_cndmask_b32 v38, v128, v132, vcc
    v_add_f32 v38, 0x358637bd, v38
    v_rcp_f32 v38, v38
    s_nop 0
    v_mul_f32 v120, v120, v38
    v_mul_f32 v121, v121, v38
    v_mul_f32 v122, v122, v38
    v_mul_f32 v123, v123, v38
    v_mul_f32 v124, v124, v38
    v_mul_f32 v125, v125, v38
    v_mul_f32 v126, v126, v38
    v_mul_f32 v127, v127, v38
    v_mul_f32 v128, v128, v38
    v_mul_f32 v129, v129, v38
    v_mul_f32 v130, v130, v38
    v_mul_f32 v131, v131, v38
    v_cvt_pk_bf16_f32 v64, v120, v121
    v_cvt_pk_bf16_f32 v65, v122, v123
    v_cvt_pk_bf16_f32 v66, v124, v125
    v_cvt_pk_bf16_f32 v67, v126, v127
    v_cvt_pk_bf16_f32 v70, v128, v129
    v_cvt_pk_bf16_f32 v71, v130, v131
    buffer_store_dwordx4 v[64:67], v5, s[20:23], s55 offen sc1
    buffer_store_dwordx4 v[68:71], v6, s[20:23], s55 offen sc1
    s_add_u32 s45, s44, 1
    s_and_b32 s45, s45, 3
    s_mul_i32 s45, s45, 15360
    s_add_u32 s45, s45, 0
    v_add_u32 v36, s45, v2
    v_add_u32 v39, 61440, v36
    s_add_u32 s45, s44, 2
    s_and_b32 s45, s45, 3
    s_mul_i32 s45, s45, 15360
    s_add_u32 s45, s45, 5120
    v_add_u32 v37, s45, v2
    v_add_u32 v40, 61440, v37
    s_add_u32 s45, s44, 3
    s_and_b32 s45, s45, 3
    s_mul_i32 s45, s45, 15360
    s_add_u32 s45, s45, 10240
    v_add_u32 v38, s45, v2
    v_add_u32 v41, 61440, v38
    s_mul_i32 s45, s44, 15360
    v_add_u32 v4, s45, v2
    v_add_u32 v5, 61440, v4
    s_waitcnt vmcnt(12)
    v_mfma_f32_16x16x32_bf16 a[0:3], a[68:71], v[236:239], a[0:3]
    s_lshl2_add_u32 s46, s51, s44
    s_mul_i32 s46, s46, 20480
    v_mfma_f32_16x16x32_bf16 a[4:7], a[72:75], v[236:239], a[4:7]
    s_mul_i32 s45, s52, 160
    s_add_u32 s46, s46, s45
    v_mfma_f32_16x16x32_bf16 a[8:11], a[76:79], v[236:239], a[8:11]
    v_and_b32 v8, 15, v1
    v_mul_u32_u24 v8, 1280, v8
    v_mfma_f32_16x16x32_bf16 a[12:15], a[80:83], v[236:239], a[12:15]
    v_mad_u32_u24 v8, v14, 40, v8
    v_add_u32 v6, s46, v8
    v_mfma_f32_16x16x32_bf16 a[16:19], a[84:87], v[236:239], a[16:19]
    buffer_load_dwordx4 a[120:123], v33, s[20:23], s40 offen sc1
    s_waitcnt vmcnt(12)
    v_mfma_f32_16x16x32_bf16 a[20:23], a[68:71], v[240:243], a[20:23]
    v_mfma_f32_16x16x32_bf16 a[24:27], a[72:75], v[240:243], a[24:27]
    v_mfma_f32_16x16x32_bf16 a[28:31], a[76:79], v[240:243], a[28:31]
    v_mfma_f32_16x16x32_bf16 a[32:35], a[80:83], v[240:243], a[32:35]
    buffer_load_dwordx4 a[200:203], v34, s[20:23], s40 offen sc1
    v_mfma_f32_16x16x32_bf16 a[36:39], a[84:87], v[240:243], a[36:39]
    s_waitcnt vmcnt(12)
    v_mfma_f32_16x16x32_bf16 a[40:43], a[68:71], a[180:183], a[40:43]
    v_mfma_f32_16x16x32_bf16 a[44:47], a[72:75], a[180:183], a[44:47]
    v_mfma_f32_16x16x32_bf16 a[48:51], a[76:79], a[180:183], a[48:51]
    v_mfma_f32_16x16x32_bf16 a[52:55], a[80:83], a[180:183], a[52:55]
    buffer_load_dwordx4 a[204:207], v35, s[20:23], s40 offen sc1
    s_add_u32 s40, s14, 2743296
    v_mfma_f32_16x16x32_bf16 a[56:59], a[84:87], a[180:183], a[56:59]
    s_waitcnt vmcnt(12)
    v_mfma_f32_16x16x32_bf16 v[184:187], a[68:71], a[184:187], v[184:187]
    v_mfma_f32_16x16x32_bf16 v[188:191], a[72:75], a[184:187], v[188:191]
    v_mfma_f32_16x16x32_bf16 v[192:195], a[76:79], a[184:187], v[192:195]
    buffer_load_dwordx4 a[208:211], v2, s[20:23], s40 offen offset:0 sc1
    v_mfma_f32_16x16x32_bf16 v[196:199], a[80:83], a[184:187], v[196:199]
    v_mfma_f32_16x16x32_bf16 v[200:203], a[84:87], a[184:187], v[200:203]
    buffer_load_dwordx4 a[212:215], v2, s[20:23], s40 offen offset:1024 sc1
    buffer_load_dwordx4 a[216:219], v2, s[20:23], s40 offen offset:2048 sc1
    buffer_load_dwordx4 a[124:127], v2, s[20:23], s40 offen offset:3072 sc1
    buffer_load_dwordx4 a[128:131], v26, s[20:23], s40 offen offset:0 sc1
    s_add_u32 s40, s16, 5500928
    s_waitcnt vmcnt(11)
    v_mfma_f32_16x16x32_bf16 a[0:3], a[88:91], v[252:255], a[0:3]
    buffer_load_dwordx4 a[132:135], v32, s[20:23], s40 offen sc1
    v_mfma_f32_16x16x32_bf16 a[4:7], a[92:95], v[252:255], a[4:7]
    v_mfma_f32_16x16x32_bf16 a[8:11], a[96:99], v[252:255], a[8:11]
    v_mfma_f32_16x16x32_bf16 a[12:15], a[100:103], v[252:255], a[12:15]
    v_mfma_f32_16x16x32_bf16 a[16:19], a[104:107], v[252:255], a[16:19]
    buffer_load_dwordx4 a[136:139], v33, s[20:23], s40 offen sc1
    buffer_load_dwordx4 a[220:223], v34, s[20:23], s40 offen sc1
    buffer_load_dwordx4 a[224:227], v35, s[20:23], s40 offen sc1
    s_add_u32 s40, s15, 2932736
    s_waitcnt vmcnt(12)
    buffer_store_dword v11, v12, s[20:23], 0 offen sc1
    s_waitcnt vmcnt(12)
    v_mfma_f32_16x16x32_bf16 a[20:23], a[88:91], a[120:123], a[20:23]
    buffer_load_dwordx4 a[228:231], v2, s[20:23], s40 offen offset:0 sc1
    v_mfma_f32_16x16x32_bf16 a[24:27], a[92:95], a[120:123], a[24:27]
    v_mfma_f32_16x16x32_bf16 a[28:31], a[96:99], a[120:123], a[28:31]
    v_mfma_f32_16x16x32_bf16 a[32:35], a[100:103], a[120:123], a[32:35]
    v_mfma_f32_16x16x32_bf16 a[36:39], a[104:107], a[120:123], a[36:39]
    s_waitcnt vmcnt(12)
    v_mfma_f32_16x16x32_bf16 a[40:43], a[88:91], a[200:203], a[40:43]
    buffer_load_dwordx4 a[232:235], v2, s[20:23], s40 offen offset:1024 sc1
    v_mfma_f32_16x16x32_bf16 a[44:47], a[92:95], a[200:203], a[44:47]
    v_mfma_f32_16x16x32_bf16 a[48:51], a[96:99], a[200:203], a[48:51]
    v_mfma_f32_16x16x32_bf16 a[52:55], a[100:103], a[200:203], a[52:55]
    v_mfma_f32_16x16x32_bf16 a[56:59], a[104:107], a[200:203], a[56:59]
    buffer_load_dwordx4 a[236:239], v2, s[20:23], s40 offen offset:2048 sc1
    s_waitcnt vmcnt(13)
    v_mfma_f32_16x16x32_bf16 v[184:187], a[88:91], a[204:207], v[184:187]
    v_mfma_f32_16x16x32_bf16 v[188:191], a[92:95], a[204:207], v[188:191]
    v_mfma_f32_16x16x32_bf16 v[192:195], a[96:99], a[204:207], v[192:195]
    v_mfma_f32_16x16x32_bf16 v[196:199], a[100:103], a[204:207], v[196:199]
    buffer_load_dwordx4 a[140:143], v2, s[20:23], s40 offen offset:3072 sc1
    v_mfma_f32_16x16x32_bf16 v[200:203], a[104:107], a[204:207], v[200:203]
    buffer_load_dwordx4 v[220:223], v26, s[20:23], s40 offen offset:0 sc1
    s_add_u32 s40, s16, 5505024
    buffer_load_dwordx4 v[224:227], v32, s[20:23], s40 offen sc1
    buffer_load_dwordx4 a[160:163], v33, s[20:23], s40 offen sc1
    buffer_load_dwordx4 a[240:243], v34, s[20:23], s40 offen sc1
    s_waitcnt vmcnt(12)
    v_mfma_f32_16x16x32_bf16 a[0:3], a[108:111], a[132:135], a[0:3]
    buffer_load_dwordx4 a[244:247], v35, s[20:23], s40 offen sc1
    v_mfma_f32_16x16x32_bf16 a[4:7], a[112:115], a[132:135], a[4:7]
    s_add_u32 s40, s15, 2937856
    v_mfma_f32_16x16x32_bf16 a[8:11], a[116:119], a[132:135], a[8:11]
    v_mfma_f32_16x16x32_bf16 a[12:15], v[208:211], a[132:135], a[12:15]
    v_mfma_f32_16x16x32_bf16 a[16:19], v[212:215], a[132:135], a[16:19]
    s_waitcnt vmcnt(12)
    v_mfma_f32_16x16x32_bf16 a[20:23], a[108:111], a[136:139], a[20:23]
    buffer_load_dwordx4 a[248:251], v2, s[20:23], s40 offen offset:0 sc1
    v_mfma_f32_16x16x32_bf16 a[24:27], a[112:115], a[136:139], a[24:27]
    v_mfma_f32_16x16x32_bf16 a[28:31], a[116:119], a[136:139], a[28:31]
    v_mfma_f32_16x16x32_bf16 a[32:35], v[208:211], a[136:139], a[32:35]
    v_mfma_f32_16x16x32_bf16 a[36:39], v[212:215], a[136:139], a[36:39]
    buffer_load_dwordx4 a[252:255], v2, s[20:23], s40 offen offset:1024 sc1
    s_waitcnt vmcnt(13)
    v_mfma_f32_16x16x32_bf16 a[40:43], a[108:111], a[220:223], a[40:43]
    v_mfma_f32_16x16x32_bf16 a[44:47], a[112:115], a[220:223], a[44:47]
    v_mfma_f32_16x16x32_bf16 a[48:51], a[116:119], a[220:223], a[48:51]
    v_mfma_f32_16x16x32_bf16 a[52:55], v[208:211], a[220:223], a[52:55]
    buffer_load_dwordx4 a[164:167], v2, s[20:23], s40 offen offset:2048 sc1
    v_mfma_f32_16x16x32_bf16 a[56:59], v[212:215], a[220:223], a[56:59]
    s_waitcnt vmcnt(13)
    v_mfma_f32_16x16x32_bf16 v[184:187], a[108:111], a[224:227], v[184:187]
    v_mfma_f32_16x16x32_bf16 v[188:191], a[112:115], a[224:227], v[188:191]
    v_mfma_f32_16x16x32_bf16 v[192:195], a[116:119], a[224:227], v[192:195]
    v_mfma_f32_16x16x32_bf16 v[196:199], v[208:211], a[224:227], v[196:199]
    buffer_load_dwordx4 v[236:239], v2, s[20:23], s40 offen offset:3072 sc1
    v_mfma_f32_16x16x32_bf16 v[200:203], v[212:215], a[224:227], v[200:203]
    buffer_load_dwordx4 v[240:243], v26, s[20:23], s40 offen offset:0 sc1
    s_add_u32 s40, s16, 5509120
    buffer_load_dwordx4 a[64:67], v32, s[20:23], s40 offen sc1
    buffer_load_dwordx4 a[180:183], v33, s[20:23], s40 offen sc1
    buffer_load_dwordx4 a[68:71], v34, s[20:23], s40 offen sc1
    s_waitcnt vmcnt(11)
    v_mfma_f32_16x16x32_bf16 a[0:3], a[144:147], v[224:227], a[0:3]
    buffer_load_dwordx4 a[72:75], v35, s[20:23], s40 offen sc1
    s_add_u32 s40, s15, 2942976
    v_mfma_f32_16x16x32_bf16 a[4:7], a[148:151], v[224:227], a[4:7]
    v_mfma_f32_16x16x32_bf16 a[8:11], a[152:155], v[224:227], a[8:11]
    v_mfma_f32_16x16x32_bf16 a[12:15], a[156:159], v[224:227], a[12:15]
    v_mfma_f32_16x16x32_bf16 a[16:19], v[216:219], v[224:227], a[16:19]
    buffer_load_dwordx4 a[184:187], v2, s[20:23], s40 offen offset:0 sc1
    s_waitcnt vmcnt(12)
    v_mfma_f32_16x16x32_bf16 a[20:23], a[144:147], a[160:163], a[20:23]
    v_mfma_f32_16x16x32_bf16 a[24:27], a[148:151], a[160:163], a[24:27]
    v_mfma_f32_16x16x32_bf16 a[28:31], a[152:155], a[160:163], a[28:31]
    v_mfma_f32_16x16x32_bf16 a[32:35], a[156:159], a[160:163], a[32:35]
    buffer_load_dwordx4 v[252:255], v2, s[20:23], s40 offen offset:1024 sc1
    v_mfma_f32_16x16x32_bf16 a[36:39], v[216:219], a[160:163], a[36:39]
    s_waitcnt vmcnt(12)
    v_mfma_f32_16x16x32_bf16 a[40:43], a[144:147], a[240:243], a[40:43]
    v_mfma_f32_16x16x32_bf16 a[44:47], a[148:151], a[240:243], a[44:47]
    v_mfma_f32_16x16x32_bf16 a[48:51], a[152:155], a[240:243], a[48:51]
    v_mfma_f32_16x16x32_bf16 a[52:55], a[156:159], a[240:243], a[52:55]
    buffer_load_dwordx4 a[120:123], v2, s[20:23], s40 offen offset:2048 sc1
    v_mfma_f32_16x16x32_bf16 a[56:59], v[216:219], a[240:243], a[56:59]
    s_waitcnt vmcnt(12)
    v_mfma_f32_16x16x32_bf16 v[184:187], a[144:147], a[244:247], v[184:187]
    v_mfma_f32_16x16x32_bf16 v[188:191], a[148:151], a[244:247], v[188:191]
    v_mfma_f32_16x16x32_bf16 v[192:195], a[152:155], a[244:247], v[192:195]
    buffer_load_dwordx4 a[200:203], v2, s[20:23], s40 offen offset:3072 sc1
    v_mfma_f32_16x16x32_bf16 v[196:199], a[156:159], a[244:247], v[196:199]
    v_mfma_f32_16x16x32_bf16 v[200:203], v[216:219], a[244:247], v[200:203]
    buffer_load_dwordx4 a[204:207], v26, s[20:23], s40 offen offset:0 sc1
    s_add_u32 s40, s16, 5513216
    buffer_load_dwordx4 a[76:79], v32, s[20:23], s40 offen sc1
    buffer_load_dwordx4 a[80:83], v33, s[20:23], s40 offen sc1
    buffer_load_dwordx4 a[84:87], v34, s[20:23], s40 offen sc1
    s_waitcnt vmcnt(11)
    v_mfma_f32_16x16x32_bf16 a[0:3], a[168:171], a[64:67], a[0:3]
    buffer_load_dwordx4 a[88:91], v35, s[20:23], s40 offen sc1
    s_add_u32 s40, s15, 2948096
    v_mfma_f32_16x16x32_bf16 a[4:7], a[172:175], a[64:67], a[4:7]
    v_mfma_f32_16x16x32_bf16 a[8:11], a[176:179], a[64:67], a[8:11]
    v_mfma_f32_16x16x32_bf16 a[12:15], v[228:231], a[64:67], a[12:15]
    v_mfma_f32_16x16x32_bf16 a[16:19], v[232:235], a[64:67], a[16:19]
    buffer_load_dwordx4 a[132:135], v2, s[20:23], s40 offen offset:0 sc1
    s_waitcnt vmcnt(12)
    v_mfma_f32_16x16x32_bf16 a[20:23], a[168:171], a[180:183], a[20:23]
    v_mfma_f32_16x16x32_bf16 a[24:27], a[172:175], a[180:183], a[24:27]
    v_mfma_f32_16x16x32_bf16 a[28:31], a[176:179], a[180:183], a[28:31]
    v_mfma_f32_16x16x32_bf16 a[32:35], v[228:231], a[180:183], a[32:35]
    buffer_load_dwordx4 a[136:139], v2, s[20:23], s40 offen offset:1024 sc1
    v_mfma_f32_16x16x32_bf16 a[36:39], v[232:235], a[180:183], a[36:39]
    s_waitcnt vmcnt(12)
    v_mfma_f32_16x16x32_bf16 a[40:43], a[168:171], a[68:71], a[40:43]
    v_mfma_f32_16x16x32_bf16 a[44:47], a[172:175], a[68:71], a[44:47]
    v_mfma_f32_16x16x32_bf16 a[48:51], a[176:179], a[68:71], a[48:51]
    v_mfma_f32_16x16x32_bf16 a[52:55], v[228:231], a[68:71], a[52:55]
    buffer_load_dwordx4 a[220:223], v2, s[20:23], s40 offen offset:2048 sc1
    v_mfma_f32_16x16x32_bf16 a[56:59], v[232:235], a[68:71], a[56:59]
    s_waitcnt vmcnt(12)
    v_mfma_f32_16x16x32_bf16 v[184:187], a[168:171], a[72:75], v[184:187]
    v_mfma_f32_16x16x32_bf16 v[188:191], a[172:175], a[72:75], v[188:191]
    v_mfma_f32_16x16x32_bf16 v[192:195], a[176:179], a[72:75], v[192:195]
    buffer_load_dwordx4 v[208:211], v2, s[20:23], s40 offen offset:3072 sc1
    v_mfma_f32_16x16x32_bf16 v[196:199], v[228:231], a[72:75], v[196:199]
    v_mfma_f32_16x16x32_bf16 v[200:203], v[232:235], a[72:75], v[200:203]
    buffer_load_dwordx4 a[224:227], v26, s[20:23], s40 offen offset:0 sc1
    s_add_u32 s40, s16, 5517312
    buffer_load_dwordx4 a[92:95], v32, s[20:23], s40 offen sc1
    buffer_load_dwordx4 a[96:99], v33, s[20:23], s40 offen sc1
    buffer_load_dwordx4 a[100:103], v34, s[20:23], s40 offen sc1
    s_waitcnt vmcnt(11)
    v_mfma_f32_16x16x32_bf16 a[0:3], a[188:191], a[76:79], a[0:3]
    buffer_load_dwordx4 a[104:107], v35, s[20:23], s40 offen sc1
    s_add_u32 s40, s15, 2953216
    v_mfma_f32_16x16x32_bf16 a[4:7], a[192:195], a[76:79], a[4:7]
    v_mfma_f32_16x16x32_bf16 a[8:11], a[196:199], a[76:79], a[8:11]
    v_mfma_f32_16x16x32_bf16 a[12:15], v[244:247], a[76:79], a[12:15]
    v_mfma_f32_16x16x32_bf16 a[16:19], v[248:251], a[76:79], a[16:19]
    buffer_load_dwordx4 v[212:215], v2, s[20:23], s40 offen offset:0 sc1
    buffer_load_dword v16, v13, s[20:23], 0 offen sc1
    s_waitcnt vmcnt(13)
    v_mfma_f32_16x16x32_bf16 a[20:23], a[188:191], a[80:83], a[20:23]
    buffer_load_dwordx4 v[44:47], v6, s[4:7], 0 offen
    buffer_load_dwordx4 v[48:51], v6, s[4:7], 0 offen offset:16
    v_mfma_f32_16x16x32_bf16 a[24:27], a[192:195], a[80:83], a[24:27]
    v_mfma_f32_16x16x32_bf16 a[28:31], a[196:199], a[80:83], a[28:31]
    v_mfma_f32_16x16x32_bf16 a[32:35], v[244:247], a[80:83], a[32:35]
    v_mfma_f32_16x16x32_bf16 a[36:39], v[248:251], a[80:83], a[36:39]
    buffer_load_dwordx2 v[52:53], v6, s[4:7], 0 offen offset:32
    s_waitcnt vmcnt(15)
    v_mfma_f32_16x16x32_bf16 a[40:43], a[188:191], a[84:87], a[40:43]
    v_mfma_f32_16x16x32_bf16 a[44:47], a[192:195], a[84:87], a[44:47]
    v_mfma_f32_16x16x32_bf16 a[48:51], a[196:199], a[84:87], a[48:51]
    v_mfma_f32_16x16x32_bf16 a[52:55], v[244:247], a[84:87], a[52:55]
    v_mfma_f32_16x16x32_bf16 a[56:59], v[248:251], a[84:87], a[56:59]
    s_waitcnt vmcnt(14)
    v_mfma_f32_16x16x32_bf16 v[184:187], a[188:191], a[88:91], v[184:187]
    v_mfma_f32_16x16x32_bf16 v[188:191], a[192:195], a[88:91], v[188:191]
    v_mfma_f32_16x16x32_bf16 v[192:195], a[196:199], a[88:91], v[192:195]
    v_mfma_f32_16x16x32_bf16 v[196:199], v[244:247], a[88:91], v[196:199]
    v_mfma_f32_16x16x32_bf16 v[200:203], v[248:251], a[88:91], v[200:203]
    buffer_load_dwordx4 v[224:227], v2, s[20:23], s40 offen offset:1024 sc1
    buffer_load_dwordx4 a[160:163], v2, s[20:23], s40 offen offset:2048 sc1
    buffer_load_dwordx4 a[240:243], v2, s[20:23], s40 offen offset:3072 sc1
    buffer_load_dwordx4 a[144:147], v26, s[20:23], s40 offen offset:0 sc1
    s_waitcnt vmcnt(12)
    v_mfma_f32_16x16x32_bf16 a[0:3], a[208:211], a[92:95], a[0:3]
    v_mfma_f32_16x16x32_bf16 a[4:7], a[212:215], a[92:95], a[4:7]
    v_mfma_f32_16x16x32_bf16 a[8:11], a[216:219], a[92:95], a[8:11]
    v_mfma_f32_16x16x32_bf16 a[12:15], a[124:127], a[92:95], a[12:15]
    v_mfma_f32_16x16x32_bf16 a[16:19], a[128:131], a[92:95], a[16:19]
    s_waitcnt vmcnt(11)
    v_mfma_f32_16x16x32_bf16 a[20:23], a[208:211], a[96:99], a[20:23]
    v_mfma_f32_16x16x32_bf16 a[24:27], a[212:215], a[96:99], a[24:27]
    v_mfma_f32_16x16x32_bf16 a[28:31], a[216:219], a[96:99], a[28:31]
    v_mfma_f32_16x16x32_bf16 a[32:35], a[124:127], a[96:99], a[32:35]
    v_mfma_f32_16x16x32_bf16 a[36:39], a[128:131], a[96:99], a[36:39]
    s_waitcnt vmcnt(10)
    v_mfma_f32_16x16x32_bf16 a[40:43], a[208:211], a[100:103], a[40:43]
    v_mfma_f32_16x16x32_bf16 a[44:47], a[212:215], a[100:103], a[44:47]
    v_mfma_f32_16x16x32_bf16 a[48:51], a[216:219], a[100:103], a[48:51]
    v_mfma_f32_16x16x32_bf16 a[52:55], a[124:127], a[100:103], a[52:55]
    v_mfma_f32_16x16x32_bf16 a[56:59], a[128:131], a[100:103], a[56:59]
    s_waitcnt vmcnt(9)
    v_mfma_f32_16x16x32_bf16 v[184:187], a[208:211], a[104:107], v[184:187]
    v_mfma_f32_16x16x32_bf16 v[188:191], a[212:215], a[104:107], v[188:191]
    v_mfma_f32_16x16x32_bf16 v[192:195], a[216:219], a[104:107], v[192:195]
    v_mfma_f32_16x16x32_bf16 v[196:199], a[124:127], a[104:107], v[196:199]
    s_waitcnt vmcnt(7)
    v_cmp_ne_u32 vcc, s47, v16
    s_nop 4
    s_cbranch_vccnz Lpoll6
Lpoll6_ret:
    v_mfma_f32_16x16x32_bf16 v[200:203], a[128:131], a[104:107], v[200:203]
    s_add_u32 s40, s17, 5668864
    buffer_load_dwordx4 a[148:151], v32, s[20:23], s40 offen sc1
    s_add_u32 s40, s17, 5672960
    buffer_load_dwordx4 a[152:155], v32, s[20:23], s40 offen sc1
    s_add_u32 s40, s17, 5677056
    ds_write_b128 v36, a[0:3] offset:0
    ds_write_b128 v36, a[4:7] offset:1024
    ds_write_b128 v36, a[8:11] offset:2048
    ds_write_b128 v36, a[12:15] offset:3072
    buffer_load_dwordx4 a[156:159], v32, s[20:23], s40 offen sc1
    s_add_u32 s40, s17, 5681152
    ds_write_b128 v36, a[16:19] offset:4096
    ds_write_b128 v37, a[20:23] offset:0
    ds_write_b128 v37, a[24:27] offset:1024
    ds_write_b128 v37, a[28:31] offset:2048
    buffer_load_dwordx4 a[244:247], v32, s[20:23], s40 offen sc1
    s_add_u32 s40, s17, 5685248
    ds_write_b128 v37, a[32:35] offset:3072
    ds_write_b128 v37, a[36:39] offset:4096
    ds_write_b128 v38, a[40:43] offset:0
    ds_write_b128 v38, a[44:47] offset:1024
    buffer_load_dwordx4 v[216:219], v32, s[20:23], s40 offen sc1
    s_add_u32 s40, s17, 5668864
    ds_write_b128 v38, a[48:51] offset:2048
    ds_write_b128 v38, a[52:55] offset:3072
    ds_write_b128 v38, a[56:59] offset:4096
    buffer_load_dwordx4 a[180:183], v33, s[20:23], s40 offen sc1
    s_add_u32 s40, s17, 5672960
    s_waitcnt lgkmcnt(0)
    s_barrier
    ds_read_b128 v[80:83], v4 offset:0
    ds_read_b128 v[84:87], v4 offset:1024
    ds_read_b128 v[88:91], v4 offset:2048
    ds_read_b128 v[92:95], v4 offset:3072
    ds_read_b128 v[96:99], v4 offset:4096
    ds_read_b128 v[100:103], v4 offset:5120
    ds_read_b128 v[104:107], v4 offset:6144
    ds_read_b128 v[108:111], v4 offset:7168
    ds_read_b128 v[112:115], v4 offset:8192
    ds_read_b128 v[116:119], v4 offset:9216
    ds_read_b128 v[120:123], v4 offset:10240
    ds_read_b128 v[124:127], v4 offset:11264
    ds_read_b128 v[128:131], v4 offset:12288
    ds_read_b128 v[132:135], v4 offset:13312
    ds_read_b128 v[136:139], v4 offset:14336
    buffer_load_dwordx4 a[168:171], v33, s[20:23], s40 offen sc1
    s_add_u32 s40, s17, 5677056
    buffer_load_dwordx4 a[172:175], v33, s[20:23], s40 offen sc1
    s_add_u32 s40, s17, 5681152
    s_waitcnt lgkmcnt(9)
    v_add_f32 v80, v80, v100
    v_add_f32 v81, v81, v101
    v_add_f32 v82, v82, v102
    v_add_f32 v83, v83, v103
    s_waitcnt lgkmcnt(8)
    v_add_f32 v84, v84, v104
    v_add_f32 v85, v85, v105
    v_add_f32 v86, v86, v106
    v_add_f32 v87, v87, v107
    s_waitcnt lgkmcnt(7)
    v_add_f32 v88, v88, v108
    v_add_f32 v89, v89, v109
    v_add_f32 v90, v90, v110
    v_add_f32 v91, v91, v111
    s_waitcnt lgkmcnt(6)
    v_add_f32 v92, v92, v112
    v_add_f32 v93, v93, v113
    v_add_f32 v94, v94, v114
    v_add_f32 v95, v95, v115
    buffer_load_dwordx4 a[176:179], v33, s[20:23], s40 offen sc1
    s_add_u32 s40, s17, 5685248
    s_waitcnt lgkmcnt(5)
    v_add_f32 v96, v96, v116
    v_add_f32 v97, v97, v117
    v_add_f32 v98, v98, v118
    v_add_f32 v99, v99, v119
    s_waitcnt lgkmcnt(4)
    v_add_f32 v80, v80, v120
    v_add_f32 v81, v81, v121
    v_add_f32 v82, v82, v122
    v_add_f32 v83, v83, v123
    s_waitcnt lgkmcnt(3)
    v_add_f32 v84, v84, v124
    v_add_f32 v85, v85, v125
    v_add_f32 v86, v86, v126
    v_add_f32 v87, v87, v127
    s_waitcnt lgkmcnt(2)
    v_add_f32 v88, v88, v128
    v_add_f32 v89, v89, v129
    v_add_f32 v90, v90, v130
    buffer_load_dwordx4 v[228:231], v33, s[20:23], s40 offen sc1
    s_add_u32 s40, s17, 5668864
    v_add_f32 v91, v91, v131
    s_waitcnt lgkmcnt(1)
    v_add_f32 v92, v92, v132
    v_add_f32 v93, v93, v133
    v_add_f32 v94, v94, v134
    v_add_f32 v95, v95, v135
    s_waitcnt lgkmcnt(0)
    v_add_f32 v96, v96, v136
    v_add_f32 v97, v97, v137
    v_add_f32 v98, v98, v138
    v_add_f32 v99, v99, v139
    v_add_f32 v184, v184, v80
    v_add_f32 v185, v185, v81
    v_add_f32 v186, v186, v82
    v_add_f32 v187, v187, v83
    v_add_f32 v188, v188, v84
    v_add_f32 v189, v189, v85
    v_add_f32 v190, v190, v86
    buffer_load_dwordx4 v[232:235], v34, s[20:23], s40 offen sc1
    s_add_u32 s40, s17, 5672960
    v_add_f32 v191, v191, v87
    v_add_f32 v192, v192, v88
    v_add_f32 v193, v193, v89
    v_add_f32 v194, v194, v90
    v_add_f32 v195, v195, v91
    v_add_f32 v196, v196, v92
    v_add_f32 v197, v197, v93
    v_add_f32 v198, v198, v94
    v_add_f32 v199, v199, v95
    v_add_f32 v200, v200, v96
    v_add_f32 v201, v201, v97
    v_add_f32 v202, v202, v98
    v_add_f32 v203, v203, v99
    s_mov_b32 s46, 0xbfb8aa3b
    v_mul_f32 v100, s46, v184
    buffer_load_dwordx4 a[188:191], v34, s[20:23], s40 offen sc1
    s_add_u32 s40, s17, 5677056
    v_mul_f32 v101, s46, v185
    v_mul_f32 v102, s46, v186
    v_mul_f32 v103, s46, v187
    v_mul_f32 v104, s46, v188
    v_mul_f32 v105, s46, v189
    v_mul_f32 v106, s46, v190
    v_mul_f32 v107, s46, v191
    v_mul_f32 v108, s46, v192
    v_mul_f32 v109, s46, v193
    v_mul_f32 v110, s46, v194
    v_mul_f32 v111, s46, v195
    v_mul_f32 v112, s46, v196
    v_mul_f32 v113, s46, v197
    v_mul_f32 v114, s46, v198
    v_mul_f32 v115, s46, v199
    v_mul_f32 v116, s46, v200
    s_waitcnt vmcnt(11)
    v_mfma_f32_16x16x32_bf16 a[60:63], a[228:231], a[148:151], 0
    buffer_load_dwordx4 a[192:195], v34, s[20:23], s40 offen sc1
    s_add_u32 s40, s17, 5681152
    v_mfma_f32_16x16x32_bf16 a[64:67], a[232:235], a[148:151], 0
    v_mul_f32 v117, s46, v201
    v_mul_f32 v118, s46, v202
    v_mfma_f32_16x16x32_bf16 a[68:71], a[236:239], a[148:151], 0
    v_mul_f32 v119, s46, v203
    v_exp_f32 v100, v100
    v_mfma_f32_16x16x32_bf16 a[72:75], a[140:143], a[148:151], 0
    v_exp_f32 v101, v101
    v_mfma_f32_16x16x32_bf16 a[76:79], v[220:223], a[148:151], 0
    buffer_load_dwordx4 a[196:199], v34, s[20:23], s40 offen sc1
    s_add_u32 s40, s17, 5685248
    s_waitcnt vmcnt(12)
    v_mfma_f32_16x16x32_bf16 a[60:63], a[248:251], a[152:155], a[60:63]
    v_exp_f32 v102, v102
    v_mfma_f32_16x16x32_bf16 a[64:67], a[252:255], a[152:155], a[64:67]
    v_exp_f32 v103, v103
    v_mfma_f32_16x16x32_bf16 a[68:71], a[164:167], a[152:155], a[68:71]
    v_exp_f32 v104, v104
    v_mfma_f32_16x16x32_bf16 a[72:75], v[236:239], a[152:155], a[72:75]
    buffer_load_dwordx4 v[244:247], v34, s[20:23], s40 offen sc1
    s_add_u32 s40, s17, 5668864
    v_mfma_f32_16x16x32_bf16 a[76:79], v[240:243], a[152:155], a[76:79]
    v_exp_f32 v105, v105
    s_waitcnt vmcnt(12)
    v_mfma_f32_16x16x32_bf16 a[60:63], a[184:187], a[156:159], a[60:63]
    v_exp_f32 v106, v106
    v_mfma_f32_16x16x32_bf16 a[64:67], v[252:255], a[156:159], a[64:67]
    v_exp_f32 v107, v107
    v_mfma_f32_16x16x32_bf16 a[68:71], a[120:123], a[156:159], a[68:71]
    v_exp_f32 v108, v108
    v_mfma_f32_16x16x32_bf16 a[72:75], a[200:203], a[156:159], a[72:75]
    buffer_load_dwordx4 v[248:251], v35, s[20:23], s40 offen sc1
    s_add_u32 s40, s17, 5672960
    v_mfma_f32_16x16x32_bf16 a[76:79], a[204:207], a[156:159], a[76:79]
    v_exp_f32 v109, v109
    s_waitcnt vmcnt(12)
    v_mfma_f32_16x16x32_bf16 a[60:63], a[132:135], a[244:247], a[60:63]
    v_exp_f32 v110, v110
    v_mfma_f32_16x16x32_bf16 a[64:67], a[136:139], a[244:247], a[64:67]
    v_exp_f32 v111, v111
    v_mfma_f32_16x16x32_bf16 a[68:71], a[220:223], a[244:247], a[68:71]
    buffer_load_dwordx4 a[208:211], v35, s[20:23], s40 offen sc1
    s_add_u32 s40, s17, 5677056
    v_mfma_f32_16x16x32_bf16 a[72:75], v[208:211], a[244:247], a[72:75]
    v_exp_f32 v112, v112
    v_mfma_f32_16x16x32_bf16 a[76:79], a[224:227], a[244:247], a[76:79]
    v_exp_f32 v113, v113
    s_waitcnt vmcnt(12)
    v_mfma_f32_16x16x32_bf16 a[60:63], v[212:215], v[216:219], a[60:63]
    v_exp_f32 v114, v114
    v_mfma_f32_16x16x32_bf16 a[64:67], v[224:227], v[216:219], a[64:67]
    buffer_load_dwordx4 a[212:215], v35, s[20:23], s40 offen sc1
    s_add_u32 s40, s17, 5681152
    v_mfma_f32_16x16x32_bf16 a[68:71], a[160:163], v[216:219], a[68:71]
    v_exp_f32 v115, v115
    v_mfma_f32_16x16x32_bf16 a[72:75], a[240:243], v[216:219], a[72:75]
    v_exp_f32 v116, v116
    v_mfma_f32_16x16x32_bf16 a[76:79], a[144:147], v[216:219], a[76:79]
    v_exp_f32 v117, v117
    s_waitcnt vmcnt(12)
    v_mfma_f32_16x16x32_bf16 a[80:83], a[228:231], a[180:183], 0
    v_exp_f32 v118, v118
    v_mfma_f32_16x16x32_bf16 a[84:87], a[232:235], a[180:183], 0
    buffer_load_dwordx4 a[216:219], v35, s[20:23], s40 offen sc1
    s_add_u32 s40, s17, 5685248
    v_mfma_f32_16x16x32_bf16 a[88:91], a[236:239], a[180:183], 0
    v_exp_f32 v119, v119
    v_mfma_f32_16x16x32_bf16 a[92:95], a[140:143], a[180:183], 0
    v_add_f32 v100, 1.0, v100
    v_add_f32 v101, 1.0, v101
    v_mfma_f32_16x16x32_bf16 a[96:99], v[220:223], a[180:183], 0
    v_add_f32 v102, 1.0, v102
    v_add_f32 v103, 1.0, v103
    s_waitcnt vmcnt(12)
    v_mfma_f32_16x16x32_bf16 a[80:83], a[248:251], a[168:171], a[80:83]
    buffer_load_dwordx4 a[124:127], v35, s[20:23], s40 offen sc1
    v_add_f32 v104, 1.0, v104
    v_mfma_f32_16x16x32_bf16 a[84:87], a[252:255], a[168:171], a[84:87]
    v_add_f32 v105, 1.0, v105
    v_add_f32 v106, 1.0, v106
    v_mfma_f32_16x16x32_bf16 a[88:91], a[164:167], a[168:171], a[88:91]
    v_add_f32 v107, 1.0, v107
    v_add_f32 v108, 1.0, v108
    v_mfma_f32_16x16x32_bf16 a[92:95], v[236:239], a[168:171], a[92:95]
    v_add_f32 v109, 1.0, v109
    v_add_f32 v110, 1.0, v110
    v_mfma_f32_16x16x32_bf16 a[96:99], v[240:243], a[168:171], a[96:99]
    v_add_f32 v111, 1.0, v111
    v_add_f32 v112, 1.0, v112
    s_waitcnt vmcnt(12)
    v_mfma_f32_16x16x32_bf16 a[80:83], a[184:187], a[172:175], a[80:83]
    v_add_f32 v113, 1.0, v113
    v_add_f32 v114, 1.0, v114
    v_mfma_f32_16x16x32_bf16 a[84:87], v[252:255], a[172:175], a[84:87]
    v_add_f32 v115, 1.0, v115
    v_add_f32 v116, 1.0, v116
    v_mfma_f32_16x16x32_bf16 a[88:91], a[120:123], a[172:175], a[88:91]
    v_add_f32 v117, 1.0, v117
    v_add_f32 v118, 1.0, v118
    v_mfma_f32_16x16x32_bf16 a[92:95], a[200:203], a[172:175], a[92:95]
    v_add_f32 v119, 1.0, v119
    v_rcp_f32 v100, v100
    v_mfma_f32_16x16x32_bf16 a[96:99], a[204:207], a[172:175], a[96:99]
    v_rcp_f32 v101, v101
    s_waitcnt vmcnt(11)
    v_mfma_f32_16x16x32_bf16 a[80:83], a[132:135], a[176:179], a[80:83]
    v_rcp_f32 v102, v102
    v_mfma_f32_16x16x32_bf16 a[84:87], a[136:139], a[176:179], a[84:87]
    v_rcp_f32 v103, v103
    v_mfma_f32_16x16x32_bf16 a[88:91], a[220:223], a[176:179], a[88:91]
    v_rcp_f32 v104, v104
    v_mfma_f32_16x16x32_bf16 a[92:95], v[208:211], a[176:179], a[92:95]
    v_rcp_f32 v105, v105
    v_mfma_f32_16x16x32_bf16 a[96:99], a[224:227], a[176:179], a[96:99]
    v_rcp_f32 v106, v106
    s_waitcnt vmcnt(10)
    v_mfma_f32_16x16x32_bf16 a[80:83], v[212:215], v[228:231], a[80:83]
    v_rcp_f32 v107, v107
    v_mfma_f32_16x16x32_bf16 a[84:87], v[224:227], v[228:231], a[84:87]
    v_rcp_f32 v108, v108
    v_mfma_f32_16x16x32_bf16 a[88:91], a[160:163], v[228:231], a[88:91]
    v_rcp_f32 v109, v109
    v_mfma_f32_16x16x32_bf16 a[92:95], a[240:243], v[228:231], a[92:95]
    v_rcp_f32 v110, v110
    v_mfma_f32_16x16x32_bf16 a[96:99], a[144:147], v[228:231], a[96:99]
    v_rcp_f32 v111, v111
    s_waitcnt vmcnt(9)
    v_mfma_f32_16x16x32_bf16 a[100:103], a[228:231], v[232:235], 0
    v_rcp_f32 v112, v112
    v_mfma_f32_16x16x32_bf16 a[104:107], a[232:235], v[232:235], 0
    v_rcp_f32 v113, v113
    v_mfma_f32_16x16x32_bf16 a[108:111], a[236:239], v[232:235], 0
    v_rcp_f32 v114, v114
    v_mfma_f32_16x16x32_bf16 a[112:115], a[140:143], v[232:235], 0
    v_rcp_f32 v115, v115
    v_mfma_f32_16x16x32_bf16 a[116:119], v[220:223], v[232:235], 0
    v_rcp_f32 v116, v116
    s_waitcnt vmcnt(8)
    v_mfma_f32_16x16x32_bf16 a[100:103], a[248:251], a[188:191], a[100:103]
    v_rcp_f32 v117, v117
    v_mfma_f32_16x16x32_bf16 a[104:107], a[252:255], a[188:191], a[104:107]
    v_rcp_f32 v118, v118
    v_mfma_f32_16x16x32_bf16 a[108:111], a[164:167], a[188:191], a[108:111]
    v_rcp_f32 v119, v119
    v_mfma_f32_16x16x32_bf16 a[112:115], v[236:239], a[188:191], a[112:115]
    v_mul_f32 v184, v100, v184
    v_mul_f32 v185, v101, v185
    v_mfma_f32_16x16x32_bf16 a[116:119], v[240:243], a[188:191], a[116:119]
    v_mul_f32 v186, v102, v186
    v_mul_f32 v187, v103, v187
    s_waitcnt vmcnt(7)
    v_mfma_f32_16x16x32_bf16 a[100:103], a[184:187], a[192:195], a[100:103]
    v_mul_f32 v188, v104, v188
    v_mul_f32 v189, v105, v189
    v_mfma_f32_16x16x32_bf16 a[104:107], v[252:255], a[192:195], a[104:107]
    v_mul_f32 v190, v106, v190
    v_mul_f32 v191, v107, v191
    v_mfma_f32_16x16x32_bf16 a[108:111], a[120:123], a[192:195], a[108:111]
    v_mul_f32 v192, v108, v192
    v_mul_f32 v193, v109, v193
    v_mfma_f32_16x16x32_bf16 a[112:115], a[200:203], a[192:195], a[112:115]
    v_mul_f32 v194, v110, v194
    v_mul_f32 v195, v111, v195
    v_mfma_f32_16x16x32_bf16 a[116:119], a[204:207], a[192:195], a[116:119]
    v_mul_f32 v196, v112, v196
    v_mul_f32 v197, v113, v197
    s_waitcnt vmcnt(6)
    v_mfma_f32_16x16x32_bf16 a[100:103], a[132:135], a[196:199], a[100:103]
    v_mul_f32 v198, v114, v198
    v_mul_f32 v199, v115, v199
    v_mfma_f32_16x16x32_bf16 a[104:107], a[136:139], a[196:199], a[104:107]
    v_mul_f32 v200, v116, v200
    v_mul_f32 v201, v117, v201
    v_mfma_f32_16x16x32_bf16 a[108:111], a[220:223], a[196:199], a[108:111]
    v_mul_f32 v202, v118, v202
    v_mul_f32 v203, v119, v203
    v_mfma_f32_16x16x32_bf16 a[112:115], v[208:211], a[196:199], a[112:115]
    v_lshlrev_b32 v160, 16, v44
    v_and_b32 v161, 0xffff0000, v44
    v_mfma_f32_16x16x32_bf16 a[116:119], a[224:227], a[196:199], a[116:119]
    v_lshlrev_b32 v162, 16, v45
    v_and_b32 v163, 0xffff0000, v45
    s_waitcnt vmcnt(5)
    v_mfma_f32_16x16x32_bf16 a[100:103], v[212:215], v[244:247], a[100:103]
    v_lshlrev_b32 v164, 16, v46
    v_and_b32 v165, 0xffff0000, v46
    v_mfma_f32_16x16x32_bf16 a[104:107], v[224:227], v[244:247], a[104:107]
    v_lshlrev_b32 v166, 16, v47
    v_and_b32 v167, 0xffff0000, v47
    v_mfma_f32_16x16x32_bf16 a[108:111], a[160:163], v[244:247], a[108:111]
    v_lshlrev_b32 v168, 16, v48
    v_and_b32 v169, 0xffff0000, v48
    v_mfma_f32_16x16x32_bf16 a[112:115], a[240:243], v[244:247], a[112:115]
    v_lshlrev_b32 v170, 16, v49
    v_and_b32 v171, 0xffff0000, v49
    v_mfma_f32_16x16x32_bf16 a[116:119], a[144:147], v[244:247], a[116:119]
    v_lshlrev_b32 v172, 16, v50
    v_and_b32 v173, 0xffff0000, v50
    s_waitcnt vmcnt(4)
    v_mfma_f32_16x16x32_bf16 v[140:143], a[228:231], v[248:251], 0
    v_lshlrev_b32 v174, 16, v51
    v_and_b32 v175, 0xffff0000, v51
    v_mfma_f32_16x16x32_bf16 v[144:147], a[232:235], v[248:251], 0
    v_lshlrev_b32 v176, 16, v52
    v_and_b32 v177, 0xffff0000, v52
    v_mfma_f32_16x16x32_bf16 v[148:151], a[236:239], v[248:251], 0
    v_lshlrev_b32 v178, 16, v53
    v_and_b32 v179, 0xffff0000, v53
    v_mfma_f32_16x16x32_bf16 v[152:155], a[140:143], v[248:251], 0
    ds_write_b128 v39, a[60:63] offset:0
    v_mfma_f32_16x16x32_bf16 v[156:159], v[220:223], v[248:251], 0
    ds_write_b128 v39, a[64:67] offset:1024
    s_waitcnt vmcnt(3)
    v_mfma_f32_16x16x32_bf16 v[140:143], a[248:251], a[208:211], v[140:143]
    ds_write_b128 v39, a[68:71] offset:2048
    v_mfma_f32_16x16x32_bf16 v[144:147], a[252:255], a[208:211], v[144:147]
    ds_write_b128 v39, a[72:75] offset:3072
    v_mfma_f32_16x16x32_bf16 v[148:151], a[164:167], a[208:211], v[148:151]
    ds_write_b128 v39, a[76:79] offset:4096
    v_mfma_f32_16x16x32_bf16 v[152:155], v[236:239], a[208:211], v[152:155]
    ds_write_b128 v40, a[80:83] offset:0
    v_mfma_f32_16x16x32_bf16 v[156:159], v[240:243], a[208:211], v[156:159]
    ds_write_b128 v40, a[84:87] offset:1024
    s_waitcnt vmcnt(2)
    v_mfma_f32_16x16x32_bf16 v[140:143], a[184:187], a[212:215], v[140:143]
    ds_write_b128 v40, a[88:91] offset:2048
    v_mfma_f32_16x16x32_bf16 v[144:147], v[252:255], a[212:215], v[144:147]
    ds_write_b128 v40, a[92:95] offset:3072
    v_mfma_f32_16x16x32_bf16 v[148:151], a[120:123], a[212:215], v[148:151]
    ds_write_b128 v40, a[96:99] offset:4096
    v_mfma_f32_16x16x32_bf16 v[152:155], a[200:203], a[212:215], v[152:155]
    ds_write_b128 v41, a[100:103] offset:0
    v_mfma_f32_16x16x32_bf16 v[156:159], a[204:207], a[212:215], v[156:159]
    ds_write_b128 v41, a[104:107] offset:1024
    s_waitcnt vmcnt(1)
    v_mfma_f32_16x16x32_bf16 v[140:143], a[132:135], a[216:219], v[140:143]
    ds_write_b128 v41, a[108:111] offset:2048
    v_mfma_f32_16x16x32_bf16 v[144:147], a[136:139], a[216:219], v[144:147]
    ds_write_b128 v41, a[112:115] offset:3072
    v_mfma_f32_16x16x32_bf16 v[148:151], a[220:223], a[216:219], v[148:151]
    ds_write_b128 v41, a[116:119] offset:4096
    v_mfma_f32_16x16x32_bf16 v[152:155], v[208:211], a[216:219], v[152:155]
    s_waitcnt lgkmcnt(0)
    s_barrier
    ds_read_b128 v[80:83], v5 offset:0
    v_mfma_f32_16x16x32_bf16 v[156:159], a[224:227], a[216:219], v[156:159]
    ds_read_b128 v[84:87], v5 offset:1024
    ds_read_b128 v[88:91], v5 offset:2048
    s_waitcnt vmcnt(0)
    v_mfma_f32_16x16x32_bf16 v[140:143], v[212:215], a[124:127], v[140:143]
    ds_read_b128 v[92:95], v5 offset:3072
    ds_read_b128 v[96:99], v5 offset:4096
    v_mfma_f32_16x16x32_bf16 v[144:147], v[224:227], a[124:127], v[144:147]
    ds_read_b128 v[100:103], v5 offset:5120
    ds_read_b128 v[104:107], v5 offset:6144
    v_mfma_f32_16x16x32_bf16 v[148:151], a[160:163], a[124:127], v[148:151]
    ds_read_b128 v[108:111], v5 offset:7168
    ds_read_b128 v[112:115], v5 offset:8192
    v_mfma_f32_16x16x32_bf16 v[152:155], a[240:243], a[124:127], v[152:155]
    ds_read_b128 v[116:119], v5 offset:9216
    ds_read_b128 v[120:123], v5 offset:10240
    v_mfma_f32_16x16x32_bf16 v[156:159], a[144:147], a[124:127], v[156:159]
    ds_read_b128 v[124:127], v5 offset:11264
    ds_read_b128 v[128:131], v5 offset:12288
    ds_read_b128 v[132:135], v5 offset:13312
    ds_read_b128 v[136:139], v5 offset:14336
    s_waitcnt lgkmcnt(9)
    v_pk_add_f32 v[80:81], v[80:81], v[100:101]
    v_pk_add_f32 v[82:83], v[82:83], v[102:103]
    s_waitcnt lgkmcnt(8)
    v_pk_add_f32 v[84:85], v[84:85], v[104:105]
    v_pk_add_f32 v[86:87], v[86:87], v[106:107]
    s_waitcnt lgkmcnt(7)
    v_pk_add_f32 v[88:89], v[88:89], v[108:109]
    v_pk_add_f32 v[90:91], v[90:91], v[110:111]
    s_waitcnt lgkmcnt(6)
    v_pk_add_f32 v[92:93], v[92:93], v[112:113]
    v_pk_add_f32 v[94:95], v[94:95], v[114:115]
    s_waitcnt lgkmcnt(5)
    v_pk_add_f32 v[96:97], v[96:97], v[116:117]
    v_pk_add_f32 v[98:99], v[98:99], v[118:119]
    s_waitcnt lgkmcnt(4)
    v_pk_add_f32 v[80:81], v[80:81], v[120:121]
    v_pk_add_f32 v[82:83], v[82:83], v[122:123]
    s_waitcnt lgkmcnt(3)
    v_pk_add_f32 v[84:85], v[84:85], v[124:125]
    v_pk_add_f32 v[86:87], v[86:87], v[126:127]
    s_waitcnt lgkmcnt(2)
    v_pk_add_f32 v[88:89], v[88:89], v[128:129]
    v_pk_add_f32 v[90:91], v[90:91], v[130:131]
    s_waitcnt lgkmcnt(1)
    v_pk_add_f32 v[92:93], v[92:93], v[132:133]
    v_pk_add_f32 v[94:95], v[94:95], v[134:135]
    s_waitcnt lgkmcnt(0)
    v_pk_add_f32 v[96:97], v[96:97], v[136:137]
    v_pk_add_f32 v[98:99], v[98:99], v[138:139]
    v_pk_add_f32 v[140:141], v[140:141], v[80:81]
    v_pk_add_f32 v[142:143], v[142:143], v[82:83]
    v_pk_add_f32 v[144:145], v[144:145], v[84:85]
    v_pk_add_f32 v[146:147], v[146:147], v[86:87]
    v_pk_add_f32 v[148:149], v[148:149], v[88:89]
    v_pk_add_f32 v[150:151], v[150:151], v[90:91]
    v_pk_add_f32 v[152:153], v[152:153], v[92:93]
    v_pk_add_f32 v[154:155], v[154:155], v[94:95]
    v_pk_add_f32 v[156:157], v[156:157], v[96:97]
    v_pk_add_f32 v[158:159], v[158:159], v[98:99]
    v_pk_fma_f32 v[160:161], v[140:141], v[184:185], v[160:161]
    v_pk_fma_f32 v[162:163], v[142:143], v[186:187], v[162:163]
    v_pk_fma_f32 v[164:165], v[144:145], v[188:189], v[164:165]
    v_pk_fma_f32 v[166:167], v[146:147], v[190:191], v[166:167]
    v_pk_fma_f32 v[168:169], v[148:149], v[192:193], v[168:169]
    v_pk_fma_f32 v[170:171], v[150:151], v[194:195], v[170:171]
    v_pk_fma_f32 v[172:173], v[152:153], v[196:197], v[172:173]
    v_pk_fma_f32 v[174:175], v[154:155], v[198:199], v[174:175]
    v_pk_fma_f32 v[176:177], v[156:157], v[200:201], v[176:177]
    v_pk_fma_f32 v[178:179], v[158:159], v[202:203], v[178:179]
    v_cvt_pk_bf16_f32 v44, v160, v161
    v_cvt_pk_bf16_f32 v45, v162, v163
    v_cvt_pk_bf16_f32 v46, v164, v165
    v_cvt_pk_bf16_f32 v47, v166, v167
    v_cvt_pk_bf16_f32 v48, v168, v169
    v_cvt_pk_bf16_f32 v49, v170, v171
    v_cvt_pk_bf16_f32 v50, v172, v173
    v_cvt_pk_bf16_f32 v51, v174, v175
    v_cvt_pk_bf16_f32 v52, v176, v177
    v_cvt_pk_bf16_f32 v53, v178, v179
    buffer_store_dwordx4 v[44:47], v6, s[36:39], 0 offen
    buffer_store_dwordx4 v[48:51], v6, s[36:39], 0 offen offset:16
    buffer_store_dwordx2 v[52:53], v6, s[36:39], 0 offen offset:32
Lend:
    s_endpgm
Lnonce:
    s_mov_b32 s48, 0x20000
Lnonce_loop:
    s_nop 7
    buffer_load_dword v11, v55, s[16:19], 0 offen sc1
    s_waitcnt vmcnt(0)
    v_readfirstlane_b32 s47, v11
    s_nop 3
    s_cmp_lg_u32 s47, 0
    s_cbranch_scc1 Lnonce_done
    s_sub_u32 s48, s48, 1
    s_cmp_lg_u32 s48, 0
    s_cbranch_scc1 Lnonce_loop
Lnonce_done:
    s_nop 7
    s_branch Lnonce_ret
Lpoll1:
    s_mov_b32 s48, 0x20000
Lpoll1_loop:
    s_nop 7
    buffer_load_dwordx4 v[16:19], v13, s[20:23], 0 offen sc1
    s_waitcnt vmcnt(0)
    v_xor_b32 v16, s47, v16
    v_xor_b32 v17, s47, v17
    v_xor_b32 v18, s47, v18
    v_xor_b32 v19, s47, v19
    v_or3_b32 v3, v16, v17, v18
    v_or_b32 v3, v3, v19
    v_cmp_ne_u32 vcc, 0, v3
    s_nop 7
    s_cbranch_vccz Lpoll1_done
    s_sub_u32 s48, s48, 1
    s_cmp_lg_u32 s48, 0
    s_cbranch_scc1 Lpoll1_loop
Lpoll1_done:
    s_nop 7
    s_branch Lpoll1_ret
Lpoll2:
    s_mov_b32 s48, 0x20000
Lpoll2_loop:
    s_nop 7
    buffer_load_dwordx2 v[32:33], v34, s[20:23], 0 offen sc1
    s_waitcnt vmcnt(0)
    v_cmp_ne_u32 vcc, s47, v33
    s_nop 7
    s_cbranch_vccz Lpoll2_done
    s_sub_u32 s48, s48, 1
    s_cmp_lg_u32 s48, 0
    s_cbranch_scc1 Lpoll2_loop
Lpoll2_done:
    s_nop 7
    s_branch Lpoll2_ret
Lpoll3:
    s_mov_b32 s48, 0x20000
Lpoll3_loop:
    s_nop 7
    buffer_load_dword v16, v13, s[20:23], 0 offen sc1
    s_waitcnt vmcnt(0)
    v_cmp_ne_u32 vcc, s47, v16
    s_nop 7
    s_cbranch_vccz Lpoll3_done
    s_sub_u32 s48, s48, 1
    s_cmp_lg_u32 s48, 0
    s_cbranch_scc1 Lpoll3_loop
Lpoll3_done:
    s_nop 7
    s_branch Lpoll3_ret
Lpoll4:
    s_mov_b32 s48, 0x20000
Lpoll4_loop:
    s_nop 7
    buffer_load_dword v28, v27, s[20:23], 0 offen sc1
    s_waitcnt vmcnt(0)
    v_cmp_ne_u32 vcc, s47, v28
    s_nop 7
    s_cbranch_vccz Lpoll4_done
    s_sub_u32 s48, s48, 1
    s_cmp_lg_u32 s48, 0
    s_cbranch_scc1 Lpoll4_loop
Lpoll4_done:
    s_nop 7
    s_branch Lpoll4_ret
Lpoll5:
    s_mov_b32 s48, 0x20000
Lpoll5_loop:
    s_nop 7
    buffer_load_dword v16, v13, s[20:23], 0 offen sc1
    s_waitcnt vmcnt(0)
    v_cmp_ne_u32 vcc, s47, v16
    s_nop 7
    s_cbranch_vccz Lpoll5_done
    s_sub_u32 s48, s48, 1
    s_cmp_lg_u32 s48, 0
    s_cbranch_scc1 Lpoll5_loop
Lpoll5_done:
    s_nop 7
    s_branch Lpoll5_ret
Lpoll6:
    s_mov_b32 s48, 0x20000
Lpoll6_loop:
    s_nop 7
    buffer_load_dword v16, v13, s[20:23], 0 offen sc1
    s_waitcnt vmcnt(0)
    v_cmp_ne_u32 vcc, s47, v16
    s_nop 7
    s_cbranch_vccz Lpoll6_done
    s_sub_u32 s48, s48, 1
    s_cmp_lg_u32 s48, 0
    s_cbranch_scc1 Lpoll6_loop
Lpoll6_done:
    s_nop 7
    s_branch Lpoll6_ret
Lcode_end:
    s_endpgm
.section .rodata,"a"
.p2align 6
.amdhsa_kernel recurrent_scan__linear_kernel_hedgehog__dense_activation_silu__prompt_kernel
  .amdhsa_next_free_vgpr 512
  .amdhsa_next_free_sgpr 102
  .amdhsa_accum_offset 256
  .amdhsa_group_segment_fixed_size 0
  .amdhsa_kernarg_size 80
  .amdhsa_user_sgpr_count 2
  .amdhsa_user_sgpr_kernarg_segment_ptr 1
  .amdhsa_system_sgpr_workgroup_id_x 1
  .amdhsa_float_denorm_mode_32 3
.end_amdhsa_kernel
```
